```python
import torch

def _softmax(x, axis=-1):
    return torch.softmax(x, dim=axis)
def _gelu(x):
    return torch.nn.functional.gelu(x, approximate="tanh")
def _silu(x):
    return torch.nn.functional.silu(x)
def _sigmoid(x):
    return torch.sigmoid(x)
def _layernorm(x, axis=-1, eps=1e-5):
    m = x.mean(dim=axis, keepdim=True)
    v = x.var(dim=axis, keepdim=True, unbiased=False)
    return (x - m) / torch.sqrt(v + eps)
def _scatter_add(tgt, idx, src, axis=0):
    return tgt.clone().index_add_(axis, idx, src)
def _segment_sum(src, seg, n):
    out = torch.zeros((n,) + src.shape[1:], dtype=src.dtype)
    return out.index_add_(0, seg, src)
def _pad(x, pw):
    flat = tuple(v for pair in reversed(pw) for v in pair)
    return torch.nn.functional.pad(x, flat)

kernel_name = 'standalone__cheap_equivariant_egnn__graph'

def setup_inputs():

    _w = (lambda a: (lambda t: t.to(torch.bfloat16) if t.is_floating_point() else t)(torch.as_tensor(a)))
    N, deg, D, De = 12500, 32, 128, max(0, 1)
    E = N * deg
    return {
        "h": _w((lambda *s: torch.randn(*s, dtype=torch.bfloat16) * 0.1)(N, D)),
        "pos": _w((lambda *s: torch.randn(*s, dtype=torch.bfloat16) * 0.8)(N, 3)),
        "e_attr": _w((lambda *s: torch.randn(*s, dtype=torch.bfloat16) * 0.8)(E, De)),
        "src": _w((lambda lo, hi, *s: torch.randint(lo, hi, s))(0, N, E).to(torch.int64)),
        "dst": _w((lambda lo, hi, *s: torch.randint(lo, hi, s))(0, N, E).to(torch.int64)),
        "w_e": _w(0.1 * (lambda *s: torch.randn(*s, dtype=torch.bfloat16) * 0.8)(2 * D + 1 + De, D)),
        "w_x": _w(0.1 * (lambda *s: torch.randn(*s, dtype=torch.bfloat16) * 0.1)(D, 1)),
        "w_h": _w(0.1 * (lambda *s: torch.randn(*s, dtype=torch.bfloat16) * 0.1)(2 * D, D)),
    }

def reference(h, pos, e_attr, src, dst, w_e, w_x, w_h):
    N, D = h.shape[0], h.shape[1]
    diff = pos[dst] - pos[src]
    dist2 = torch.sum(diff * diff, axis=-1, keepdims=True)
    e_in = torch.concatenate([h[dst], h[src], dist2, e_attr], axis=-1)
    m_ij = _silu(e_in @ w_e)
    coord_scale = m_ij @ w_x
    pos_new = pos + _segment_sum(diff * coord_scale, dst, N)
    m_i = _segment_sum(m_ij, dst, N)
    h_new = h + _silu(torch.concatenate([h, m_i], axis=-1) @ w_h)
    return h_new, pos_new
```

```asm
; @launch kernel=k1_kernel grid=(512,1,1) block=(512,1,1) lds=49152
; @launch kernel=standalone__cheap_equivariant_egnn__graph_kernel grid=(256,1,1) block=(512,1,1) lds=163712
.amdgcn_target "amdgcn-amd-amdhsa--gfx950"
.text
.p2align 12
.fill 832, 4, 0xbf810000
.globl k1_kernel
.p2align 8
.type k1_kernel,@function
k1_kernel:
    s_load_dwordx2 s[4:5], s[0:1], 32
    s_load_dwordx2 s[8:9], s[0:1], 24
    s_load_dwordx2 s[12:13], s[0:1], 16
    s_load_dwordx2 s[16:17], s[0:1], 80
    s_load_dwordx2 s[20:21], s[0:1], 0
    s_load_dwordx2 s[24:25], s[0:1], 40
    s_load_dwordx2 s[28:29], s[0:1], 56
    s_cmp_ge_u32 s2, 512
    s_cbranch_scc1 K1_EXIT
    v_lshrrev_b32 v1, 6, v0
    v_and_b32 v2, 63, v0
    s_mov_b32 s18, 3576832
    s_mov_b32 s19, 131072
    v_readfirstlane_b32 s3, v1
    s_and_b32 s60, s2, 255
    s_cmp_ge_u32 s2, 256
    s_cbranch_scc1 K1_SORT
    s_and_b32 s40, s60, 7
    s_lshl_b32 s40, s40, 5
    s_lshr_b32 s41, s60, 3
    s_add_u32 s40, s40, s41
    s_mul_i32 s40, s40, 12544
    s_sub_u32 s22, 3200000, s40
    s_min_u32 s22, s22, 12544
    s_mov_b32 s23, s19
    s_mov_b32 s26, 66048
    s_mov_b32 s27, s19
    v_lshrrev_b32 v3, 4, v2
    v_and_b32 v4, 15, v2
    v_xor_b32 v5, v3, v4
    v_lshlrev_b32 v5, 4, v5
    v_lshl_or_b32 v5, v3, 8, v5
    v_xor_b32 v6, 64, v5
    v_xor_b32 v7, 128, v5
    v_xor_b32 v8, 192, v5
    s_lshl_b32 s42, s3, 12
    s_add_u32 s43, s42, 32768
    s_mov_b32 m0, s42
    s_and_b32 s44, s42, 8192
    s_or_b32 s45, s42, 4096
    s_waitcnt lgkmcnt(0)
    s_add_u32 s20, s20, s40
    s_addc_u32 s21, s21, 0
    buffer_load_dwordx4 v5, s[24:27], s43 offen lds
    buffer_load_dwordx4 v5, s[24:27], s43 offen offset:1024 lds
    buffer_load_dwordx4 v6, s[24:27], s43 offen offset:2048 lds
    buffer_load_dwordx4 v6, s[24:27], s43 offen offset:3072 lds
    s_cmp_ge_u32 s3, 4
    s_cbranch_scc1 K1_REPACK
    s_mov_b32 m0, s43
    s_nop 0
    buffer_load_dwordx4 v5, s[20:23], s42 offen offset:0 lds
    buffer_load_dwordx4 v6, s[20:23], s42 offen offset:1024 lds
    buffer_load_dwordx4 v7, s[20:23], s42 offen offset:2048 lds
    buffer_load_dwordx4 v8, s[20:23], s42 offen offset:3072 lds
    s_branch K1_GEMM
K1_SORT:
    s_cmp_eq_u32 s3, 7
    s_cbranch_scc1 K1_WARM
    s_setprio 0
    s_mov_b32 s6, 1600000
    s_mov_b32 s7, s19
    s_mov_b32 s10, s6
    s_mov_b32 s11, s19
    s_mov_b32 s14, 800000
    s_mov_b32 s15, s19
    s_mul_i32 s42, s60, 3128
    s_lshl_b32 s41, s42, 1
    v_lshlrev_b32 v3, 4, v0
    v_lshlrev_b32 v14, 3, v0
    v_lshlrev_b32 v15, 2, v0
    v_mov_b32 v40, 0
    s_movk_i32 s43, 391
    s_cmp_eq_u32 s60, 255
    s_cselect_b32 s43, 295, s43
    v_cmp_gt_u32 vcc, s43, v0
    ds_write_b32 v15, v40
    s_mov_b32 s46, -49
    s_mov_b32 s47, 0xff100000
    s_mov_b32 s54, 0x54000000
    s_mov_b32 s48, 3216550459
    s_mov_b32 s49, s48
    s_mov_b32 s50, 0xffff0000
    s_mul_i32 s51, s60, 12544
    s_lshl_b32 s52, s60, 4
    s_add_u32 s52, s52, 3310592
    s_add_u32 s53, s51, 7168
    v_mov_b32 v41, 1
    v_lshlrev_b32 v42, 4, v2
    s_mov_b64 s[44:45], vcc
    s_mov_b64 exec, vcc
    s_waitcnt lgkmcnt(0)
    buffer_load_dwordx4 v[4:7], v3, s[4:7], s41 offen
    buffer_load_dwordx2 v[12:13], v14, s[12:15], s42 offen
    buffer_load_dwordx4 v[8:11], v3, s[8:11], s41 offen
    s_barrier
    s_waitcnt vmcnt(2)
    v_mul_u32_u24 v24, 21400, v4
    v_mul_u32_u24 v25, 21400, v5
    v_mul_u32_u24 v26, 21400, v6
    v_mul_u32_u24 v27, 21400, v7
    v_lshrrev_b32 v24, 20, v24
    v_lshrrev_b32 v25, 20, v25
    v_lshrrev_b32 v26, 20, v26
    v_lshrrev_b32 v27, 20, v27
    v_lshlrev_b32 v16, 2, v24
    ds_add_rtn_u32 v20, v16, v41
    v_lshlrev_b32 v17, 2, v25
    ds_add_rtn_u32 v21, v17, v41
    v_lshlrev_b32 v18, 2, v26
    ds_add_rtn_u32 v22, v18, v41
    v_lshlrev_b32 v19, 2, v27
    ds_add_rtn_u32 v23, v19, v41
    v_mad_i32_i24 v4, v24, s46, v4
    v_mad_i32_i24 v5, v25, s46, v5
    v_mad_i32_i24 v6, v26, s46, v6
    v_mad_i32_i24 v7, v27, s46, v7
    v_mul_u32_u24 v24, 43, v4
    v_mul_u32_u24 v25, 43, v5
    v_mul_u32_u24 v26, 43, v6
    v_mul_u32_u24 v27, 43, v7
    v_lshrrev_b32 v24, 8, v24
    v_lshrrev_b32 v25, 8, v25
    v_lshrrev_b32 v26, 8, v26
    v_lshrrev_b32 v27, 8, v27
    v_lshl_add_u32 v49, v4, 2, 4
    v_lshl_add_u32 v51, v5, 2, 4
    v_lshl_add_u32 v53, v6, 2, 4
    v_lshl_add_u32 v55, v7, 2, 4
    v_mad_i32_i24 v4, v24, -6, v4
    v_mad_i32_i24 v5, v25, -6, v5
    v_mad_i32_i24 v6, v26, -6, v6
    v_mad_i32_i24 v7, v27, -6, v7
    s_mov_b64 exec, -1
    s_waitcnt lgkmcnt(0)
    s_barrier
    ds_read_b128 v[32:35], v42
    v_lshlrev_b32 v28, v4, s54
    v_lshlrev_b32 v29, v5, s54
    v_lshlrev_b32 v30, v6, s54
    v_lshlrev_b32 v31, v7, s54
    s_waitcnt vmcnt(1)
    v_lshlrev_b32 v24, 16, v12
    v_and_b32 v25, s50, v12
    v_lshlrev_b32 v26, 16, v13
    v_and_b32 v27, s50, v13
    v_pk_mul_f32 v[24:25], v[24:25], s[48:49]
    v_pk_mul_f32 v[26:27], v[26:27], s[48:49]
    v_cvt_pk_bf16_f32 v12, v24, v25
    v_cvt_pk_bf16_f32 v13, v26, v27
    s_waitcnt lgkmcnt(0)
    v_add_u32 v43, v32, v33
    v_add3_u32 v43, v43, v34, v35
    v_lshl_or_b32 v49, v12, 16, v49
    v_and_or_b32 v51, v12, s50, v51
    v_add_u32_dpp v44, v43, v43 row_shr:1 row_mask:0xf bank_mask:0xf bound_ctrl:1
    v_lshl_or_b32 v53, v13, 16, v53
    v_and_or_b32 v55, v13, s50, v55
    s_waitcnt vmcnt(0)
    v_add_u32_dpp v44, v44, v44 row_shr:2 row_mask:0xf bank_mask:0xf bound_ctrl:1
    v_lshl_add_u32 v8, v4, 20, v8
    v_lshl_add_u32 v9, v5, 20, v9
    v_add_u32_dpp v44, v44, v44 row_shr:4 row_mask:0xf bank_mask:0xf bound_ctrl:1
    v_lshl_add_u32 v10, v6, 20, v10
    v_lshl_add_u32 v11, v7, 20, v11
    v_add_u32_dpp v44, v44, v44 row_shr:8 row_mask:0xf bank_mask:0xf bound_ctrl:1
    v_xad_u32 v48, v28, s47, v8
    v_xad_u32 v50, v29, s47, v9
    v_add_u32_dpp v44, v44, v44 row_bcast:15 row_mask:0xa bank_mask:0xf
    v_xad_u32 v52, v30, s47, v10
    v_xad_u32 v54, v31, s47, v11
    v_add_u32_dpp v44, v44, v44 row_bcast:31 row_mask:0xc bank_mask:0xf
    v_sub_u32 v36, v44, v43
    v_add_u32 v37, v36, v32
    v_add_u32 v38, v37, v33
    v_add_u32 v39, v38, v34
    ds_write_b128 v42, v[36:39] offset:2048
    s_mov_b64 exec, s[44:45]
    ds_read_b32 v16, v16 offset:2048
    ds_read_b32 v17, v17 offset:2048
    ds_read_b32 v18, v18 offset:2048
    ds_read_b32 v19, v19 offset:2048
    s_cmp_lg_u32 s3, 6
    s_cbranch_scc1 K1_NOTAB
    s_mov_b64 exec, -1
    v_lshl_or_b32 v32, v32, 16, v36
    v_lshl_or_b32 v33, v33, 16, v37
    v_lshl_or_b32 v34, v34, 16, v38
    v_lshl_or_b32 v35, v35, 16, v39
    v_lshlrev_b32 v42, 12, v2
    buffer_store_dwordx4 v[32:35], v42, s[16:19], s52 offen sc1
    s_mov_b64 exec, s[44:45]
K1_NOTAB:
    s_waitcnt lgkmcnt(3)
    v_add_lshl_u32 v16, v16, v20, 3
    ds_write_b64 v16, v[48:49] offset:4096
    s_waitcnt lgkmcnt(3)
    v_add_lshl_u32 v17, v17, v21, 3
    ds_write_b64 v17, v[50:51] offset:4096
    s_waitcnt lgkmcnt(3)
    v_add_lshl_u32 v18, v18, v22, 3
    ds_write_b64 v18, v[52:53] offset:4096
    s_waitcnt lgkmcnt(3)
    v_add_lshl_u32 v19, v19, v23, 3
    ds_write_b64 v19, v[54:55] offset:4096
    s_mov_b64 exec, -1
    v_cmp_gt_u32 vcc, 334, v0
    s_waitcnt lgkmcnt(0)
    s_barrier
    ds_read_b128 v[4:7], v3 offset:4096
    ds_read_b128 v[8:11], v3 offset:11264
    s_waitcnt lgkmcnt(1)
    buffer_store_dwordx4 v[4:7], v3, s[16:19], s51 offen sc1
    s_mov_b64 exec, vcc
    s_waitcnt lgkmcnt(0)
    buffer_store_dwordx4 v[8:11], v3, s[16:19], s53 offen sc1
K1_EXIT:
    s_endpgm
K1_WARM:
    s_mov_b64 exec, 0
    s_bfe_u32 s40, s2, 0x40003
    s_cmp_lg_u32 s40, 0
    s_cbranch_scc0 K2_PAD0
    s_cmp_lg_u32 s40, 1
    s_cbranch_scc0 K2_PAD1
    s_cmp_lg_u32 s40, 2
    s_cbranch_scc0 K2_PAD2
    s_cmp_lg_u32 s40, 3
    s_cbranch_scc0 K2_PAD3
    s_cmp_lg_u32 s40, 4
    s_cbranch_scc0 K2_PAD4
    s_cmp_lg_u32 s40, 5
    s_cbranch_scc0 K2_PAD5
    s_cmp_lg_u32 s40, 6
    s_cbranch_scc0 K2_PAD6
    s_cmp_lg_u32 s40, 7
    s_cbranch_scc0 K2_PAD7
    s_cmp_lg_u32 s40, 8
    s_cbranch_scc0 K2_PAD8
    s_cmp_lg_u32 s40, 9
    s_cbranch_scc0 K2_PAD9
    s_cmp_lg_u32 s40, 10
    s_cbranch_scc0 K2_PAD10
    s_cmp_lg_u32 s40, 11
    s_cbranch_scc0 K2_PAD11
    s_cmp_lg_u32 s40, 12
    s_cbranch_scc0 K2_PAD12
    s_cmp_lg_u32 s40, 13
    s_cbranch_scc0 K2_PAD13
K1_PADEND:
    s_endpgm
K1_PADLINK1:
    s_cbranch_scc1 K2_PAD1
    s_endpgm
K1_PADLINK2:
    s_cbranch_scc1 K2_PAD2
    s_endpgm
K1_PADLINK3:
    s_cbranch_scc1 K2_PAD3
    s_endpgm
K1_PADLINK4:
    s_cbranch_scc1 K2_PAD4
    s_endpgm
K1_PADLINK6:
    s_cbranch_scc1 K2_PAD6
    s_endpgm
K1_PADLINK7:
    s_cbranch_scc1 K2_PAD7
    s_endpgm
K1_PADLINK9:
    s_cbranch_scc1 K2_PAD9
    s_endpgm
K1_PADLINK10:
    s_cbranch_scc1 K2_PAD10
    s_endpgm
K1_PADLINK12:
    s_cbranch_scc1 K2_PAD12
    s_endpgm
K1_PADLINK13:
    s_cbranch_scc1 K2_PAD13
    s_endpgm
K1_GEMM:
    s_and_b32 s46, s3, 1
    v_bfe_u32 v5, v2, 2, 2
    v_and_b32 v6, 1, v3
    v_lshl_or_b32 v6, v6, 2, v5
    v_lshl_or_b32 v5, v3, 3, v5
    v_xor_b32 v6, s46, v6
    v_lshlrev_b32 v5, 8, v5
    v_lshl_or_b32 v5, v6, 4, v5
    v_bfe_u32 v6, v2, 1, 1
    v_lshl_or_b32 v5, v6, 7, v5
    v_and_b32 v6, 1, v2
    v_lshl_or_b32 v8, v6, 3, v5
    v_xor_b32 v9, 32, v8
    v_xor_b32 v10, 64, v8
    v_xor_b32 v11, 96, v8
    s_add_u32 s36, s16, 4194304
    s_addc_u32 s37, s17, 0
    s_add_u32 s36, s36, s40
    s_addc_u32 s37, s37, 0
    s_mov_b32 s38, 12544
    s_mov_b32 s39, s19
    s_mov_b32 s48, 3216550459
    s_mov_b32 s49, s48
    s_lshl_b32 s46, s46, 7
    v_and_b32 v5, 7, v2
    v_lshl_or_b32 v5, v5, 4, s46
    v_and_or_b32 v5, v2, 8, v5
    v_lshl_or_b32 v5, v3, 10, v5
    v_xor_b32 v6, v3, v4
    v_lshlrev_b32 v6, 4, v6
    v_lshl_or_b32 v6, v4, 8, v6
    v_add_u32 v96, s44, v6
    v_xor_b32 v97, 64, v96
    v_xor_b32 v98, 128, v96
    v_xor_b32 v99, 192, v96
    s_waitcnt vmcnt(0)
    s_barrier
    ds_read_b128 v[12:15], v96 offset:32768
    ds_read_b128 v[16:19], v96 offset:36864
    ds_read_b64_tr_b16 v[44:45], v8 offset:0
    ds_read_b64_tr_b16 v[46:47], v8 offset:1024
    ds_read_b64_tr_b16 v[48:49], v9 offset:0
    ds_read_b64_tr_b16 v[50:51], v9 offset:1024
    ds_read_b64_tr_b16 v[52:53], v10 offset:0
    ds_read_b64_tr_b16 v[54:55], v10 offset:1024
    ds_read_b64_tr_b16 v[56:57], v11 offset:0
    ds_read_b64_tr_b16 v[58:59], v11 offset:1024
    s_waitcnt lgkmcnt(6)
    v_mfma_f32_16x16x32_bf16 v[64:67], v[12:15], v[44:47], 0
    v_mfma_f32_16x16x32_bf16 v[80:83], v[16:19], v[44:47], 0
    ds_read_b128 v[20:23], v97 offset:32768
    ds_read_b128 v[24:27], v97 offset:36864
    ds_read_b64_tr_b16 v[60:61], v8 offset:8192
    ds_read_b64_tr_b16 v[62:63], v8 offset:9216
    s_waitcnt lgkmcnt(8)
    v_mfma_f32_16x16x32_bf16 v[68:71], v[12:15], v[48:51], 0
    v_mfma_f32_16x16x32_bf16 v[84:87], v[16:19], v[48:51], 0
    ds_read_b64_tr_b16 v[44:45], v9 offset:8192
    ds_read_b64_tr_b16 v[46:47], v9 offset:9216
    s_waitcnt lgkmcnt(8)
    v_mfma_f32_16x16x32_bf16 v[72:75], v[12:15], v[52:55], 0
    v_mfma_f32_16x16x32_bf16 v[88:91], v[16:19], v[52:55], 0
    ds_read_b64_tr_b16 v[48:49], v10 offset:8192
    ds_read_b64_tr_b16 v[50:51], v10 offset:9216
    s_waitcnt lgkmcnt(8)
    v_mfma_f32_16x16x32_bf16 v[76:79], v[12:15], v[56:59], 0
    v_mfma_f32_16x16x32_bf16 v[92:95], v[16:19], v[56:59], 0
    ds_read_b64_tr_b16 v[52:53], v11 offset:8192
    ds_read_b64_tr_b16 v[54:55], v11 offset:9216
    s_waitcnt lgkmcnt(6)
    v_mfma_f32_16x16x32_bf16 v[64:67], v[20:23], v[60:63], v[64:67]
    v_mfma_f32_16x16x32_bf16 v[80:83], v[24:27], v[60:63], v[80:83]
    s_barrier
    ds_read_b128 v[28:31], v98 offset:32768
    ds_read_b128 v[32:35], v98 offset:36864
    ds_read_b64_tr_b16 v[56:57], v8 offset:16384
    ds_read_b64_tr_b16 v[58:59], v8 offset:17408
    s_waitcnt lgkmcnt(8)
    v_mfma_f32_16x16x32_bf16 v[68:71], v[20:23], v[44:47], v[68:71]
    v_mfma_f32_16x16x32_bf16 v[84:87], v[24:27], v[44:47], v[84:87]
    ds_read_b64_tr_b16 v[60:61], v9 offset:16384
    ds_read_b64_tr_b16 v[62:63], v9 offset:17408
    s_waitcnt lgkmcnt(8)
    v_mfma_f32_16x16x32_bf16 v[72:75], v[20:23], v[48:51], v[72:75]
    v_mfma_f32_16x16x32_bf16 v[88:91], v[24:27], v[48:51], v[88:91]
    ds_read_b64_tr_b16 v[44:45], v10 offset:16384
    ds_read_b64_tr_b16 v[46:47], v10 offset:17408
    s_waitcnt lgkmcnt(8)
    v_mfma_f32_16x16x32_bf16 v[76:79], v[20:23], v[52:55], v[76:79]
    v_mfma_f32_16x16x32_bf16 v[92:95], v[24:27], v[52:55], v[92:95]
    ds_read_b64_tr_b16 v[48:49], v11 offset:16384
    ds_read_b64_tr_b16 v[50:51], v11 offset:17408
    s_waitcnt lgkmcnt(6)
    v_mfma_f32_16x16x32_bf16 v[64:67], v[28:31], v[56:59], v[64:67]
    v_mfma_f32_16x16x32_bf16 v[80:83], v[32:35], v[56:59], v[80:83]
    ds_read_b128 v[36:39], v99 offset:32768
    ds_read_b128 v[40:43], v99 offset:36864
    ds_read_b64_tr_b16 v[52:53], v8 offset:24576
    ds_read_b64_tr_b16 v[54:55], v8 offset:25600
    s_waitcnt lgkmcnt(8)
    v_mfma_f32_16x16x32_bf16 v[68:71], v[28:31], v[60:63], v[68:71]
    v_mfma_f32_16x16x32_bf16 v[84:87], v[32:35], v[60:63], v[84:87]
    ds_read_b64_tr_b16 v[56:57], v9 offset:24576
    ds_read_b64_tr_b16 v[58:59], v9 offset:25600
    s_waitcnt lgkmcnt(8)
    v_mfma_f32_16x16x32_bf16 v[72:75], v[28:31], v[44:47], v[72:75]
    v_mfma_f32_16x16x32_bf16 v[88:91], v[32:35], v[44:47], v[88:91]
    ds_read_b64_tr_b16 v[60:61], v10 offset:24576
    ds_read_b64_tr_b16 v[62:63], v10 offset:25600
    s_waitcnt lgkmcnt(8)
    v_mfma_f32_16x16x32_bf16 v[76:79], v[28:31], v[48:51], v[76:79]
    v_mfma_f32_16x16x32_bf16 v[92:95], v[32:35], v[48:51], v[92:95]
    ds_read_b64_tr_b16 v[44:45], v11 offset:24576
    ds_read_b64_tr_b16 v[46:47], v11 offset:25600
    s_waitcnt lgkmcnt(6)
    v_mfma_f32_16x16x32_bf16 v[64:67], v[36:39], v[52:55], v[64:67]
    v_mfma_f32_16x16x32_bf16 v[80:83], v[40:43], v[52:55], v[80:83]
    s_waitcnt lgkmcnt(4)
    v_mfma_f32_16x16x32_bf16 v[68:71], v[36:39], v[56:59], v[68:71]
    v_mfma_f32_16x16x32_bf16 v[84:87], v[40:43], v[56:59], v[84:87]
    s_waitcnt lgkmcnt(2)
    v_mfma_f32_16x16x32_bf16 v[72:75], v[36:39], v[60:63], v[72:75]
    v_mfma_f32_16x16x32_bf16 v[88:91], v[40:43], v[60:63], v[88:91]
    s_waitcnt lgkmcnt(0)
    v_mfma_f32_16x16x32_bf16 v[76:79], v[36:39], v[44:47], v[76:79]
    v_mfma_f32_16x16x32_bf16 v[92:95], v[40:43], v[44:47], v[92:95]
    v_pk_mul_f32 v[64:65], v[64:65], s[48:49]
    v_pk_mul_f32 v[66:67], v[66:67], s[48:49]
    v_pk_mul_f32 v[68:69], v[68:69], s[48:49]
    v_pk_mul_f32 v[70:71], v[70:71], s[48:49]
    v_pk_mul_f32 v[72:73], v[72:73], s[48:49]
    v_pk_mul_f32 v[74:75], v[74:75], s[48:49]
    s_nop 0
    v_pk_mul_f32 v[76:77], v[76:77], s[48:49]
    v_pk_mul_f32 v[78:79], v[78:79], s[48:49]
    v_cvt_pk_bf16_f32 v12, v64, v68
    v_cvt_pk_bf16_f32 v13, v72, v76
    buffer_store_dwordx2 v[12:13], v5, s[36:39], s44 offen offset:0 sc1
    v_cvt_pk_bf16_f32 v14, v65, v69
    v_cvt_pk_bf16_f32 v15, v73, v77
    buffer_store_dwordx2 v[14:15], v5, s[36:39], s44 offen offset:256 sc1
    v_cvt_pk_bf16_f32 v16, v66, v70
    v_cvt_pk_bf16_f32 v17, v74, v78
    buffer_store_dwordx2 v[16:17], v5, s[36:39], s44 offen offset:512 sc1
    v_cvt_pk_bf16_f32 v18, v67, v71
    v_cvt_pk_bf16_f32 v19, v75, v79
    buffer_store_dwordx2 v[18:19], v5, s[36:39], s44 offen offset:768 sc1
    v_pk_mul_f32 v[80:81], v[80:81], s[48:49]
    v_pk_mul_f32 v[82:83], v[82:83], s[48:49]
    v_pk_mul_f32 v[84:85], v[84:85], s[48:49]
    v_pk_mul_f32 v[86:87], v[86:87], s[48:49]
    v_pk_mul_f32 v[88:89], v[88:89], s[48:49]
    v_pk_mul_f32 v[90:91], v[90:91], s[48:49]
    v_pk_mul_f32 v[92:93], v[92:93], s[48:49]
    v_pk_mul_f32 v[94:95], v[94:95], s[48:49]
    v_cvt_pk_bf16_f32 v20, v80, v84
    v_cvt_pk_bf16_f32 v21, v88, v92
    buffer_store_dwordx2 v[20:21], v5, s[36:39], s45 offen offset:0 sc1
    v_cvt_pk_bf16_f32 v22, v81, v85
    v_cvt_pk_bf16_f32 v23, v89, v93
    buffer_store_dwordx2 v[22:23], v5, s[36:39], s45 offen offset:256 sc1
    v_cvt_pk_bf16_f32 v24, v82, v86
    v_cvt_pk_bf16_f32 v25, v90, v94
    buffer_store_dwordx2 v[24:25], v5, s[36:39], s45 offen offset:512 sc1
    v_cvt_pk_bf16_f32 v26, v83, v87
    v_cvt_pk_bf16_f32 v27, v91, v95
    buffer_store_dwordx2 v[26:27], v5, s[36:39], s45 offen offset:768 sc1
    s_endpgm
K1_REPACK:
    s_mov_b32 s30, 65536
    s_mov_b32 s31, 131072
    s_cmp_eq_u32 s3, 7
    s_cbranch_scc1 K1_CONST
    s_mul_i32 s46, s60, 3
    s_add_u32 s46, s46, s3
    s_sub_u32 s46, s46, 4
    s_bfe_u32 s47, s46, 0x20006
    s_bfe_u32 s48, s46, 0x30003
    s_bfe_u32 s49, s46, 0x10002
    s_bfe_u32 s50, s46, 0x10001
    s_and_b32 s51, s46, 1
    v_and_b32 v3, 7, v2
    v_lshrrev_b32 v4, 3, v2
    s_lshl_b32 s52, s48, 1
    s_add_u32 s52, s52, s49
    s_lshl_b32 s52, s52, 10
    s_lshl_b32 s55, s46, 7
    s_add_u32 s55, s55, 3211264
    v_lshlrev_b32 v7, 1, v2
    s_cmp_ge_u32 s46, 256
    s_cbranch_scc1 K1_RP_H
    s_lshr_b32 s53, s47, 1
    s_lshl_b32 s53, s53, 3
    s_and_b32 s54, s47, 1
    s_add_u32 s53, s53, s54
    s_lshl_b32 s54, s50, 2
    s_add_u32 s53, s53, s54
    s_lshl_b32 s54, s51, 1
    s_add_u32 s53, s53, s54
    s_add_u32 s52, s52, s53
    s_lshl_b32 s52, s52, 1
    v_lshlrev_b32 v5, 8, v3
    v_lshl_or_b32 v5, v4, 5, v5
    buffer_load_ushort v6, v5, s[24:27], s52 offen
    s_branch K1_RP_ST
K1_RP_H:
    s_lshl_b32 s53, s47, 5
    s_lshl_b32 s54, s51, 4
    s_add_u32 s53, s53, s54
    s_add_u32 s53, s53, s50
    v_lshlrev_b32 v5, 8, v3
    s_cmp_ge_u32 s46, 512
    s_cbranch_scc0 K1_RP_H1
    s_lshr_b32 s52, s48, 2
    s_lshl_b32 s52, s52, 2
    s_and_b32 s54, s48, 1
    s_lshl_b32 s54, s54, 6
    s_add_u32 s52, s52, s54
    s_lshl_b32 s54, s49, 5
    s_add_u32 s52, s52, s54
    s_and_b32 s54, s48, 2
    s_add_u32 s52, s52, s54
    s_add_u32 s52, s52, 128
    s_lshl_b32 s52, s52, 7
    v_lshrrev_b32 v5, 1, v3
    v_lshlrev_b32 v5, 11, v5
    v_and_b32 v6, 1, v3
    v_lshl_or_b32 v5, v6, 8, v5
K1_RP_H1:
    s_add_u32 s52, s52, s53
    s_lshl_b32 s52, s52, 1
    v_lshl_or_b32 v5, v4, 2, v5
    buffer_load_ushort v6, v5, s[28:31], s52 offen
K1_RP_ST:
    s_barrier
    s_waitcnt vmcnt(1)
    s_barrier
    s_waitcnt vmcnt(0)
    buffer_store_short v6, v7, s[16:19], s55 offen sc1
    s_mov_b64 exec, 0
    s_cmp_eq_u32 s3, 4
    s_cbranch_scc1 K2_PAD0
    s_cmp_eq_u32 s3, 5
    s_cbranch_scc1 K2_PAD5
    s_cmp_eq_u32 s3, 6
    s_branch K2_PAD8
K1_CONST:
    s_load_dwordx2 s[32:33], s[0:1], 48
    s_load_dwordx2 s[56:57], s[0:1], 8
    s_mov_b32 s58, 75000
    s_mov_b32 s59, 131072
    s_mul_i32 s46, s41, 2432
    v_lshlrev_b32 v3, 7, v2
    s_waitcnt lgkmcnt(0)
    s_mov_b64 exec, 524287
    buffer_load_dword v16, v3, s[56:59], s46 offen
    s_mov_b64 exec, -1
    s_cmp_eq_u32 s60, 0
    s_cbranch_scc1 K1_CONST0
    s_barrier
    s_waitcnt vmcnt(1)
    s_barrier
    s_branch K1_EXIT2
K1_CONST0:
    s_mov_b32 s34, 256
    s_mov_b32 s35, 131072
    s_mov_b32 s46, 65536
    s_mov_b32 s47, 3309568
    v_and_b32 v3, 7, v2
    v_lshlrev_b32 v3, 5, v3
    v_bfe_u32 v4, v2, 4, 1
    v_lshl_or_b32 v3, v4, 3, v3
    v_bfe_u32 v4, v2, 3, 1
    v_lshl_or_b32 v3, v4, 2, v3
    v_lshrrev_b32 v4, 5, v2
    v_lshl_or_b32 v4, v4, 1, v3
    buffer_load_ushort v8, v4, s[24:27], s46 offen
    buffer_load_ushort v9, v4, s[24:27], s46 offen offset:16
    buffer_load_ushort v10, v4, s[24:27], s46 offen offset:256
    buffer_load_ushort v11, v4, s[24:27], s46 offen offset:272
    buffer_load_ushort v12, v3, s[32:35], 0 offen
    buffer_load_ushort v13, v3, s[32:35], 0 offen offset:2
    buffer_load_ushort v14, v3, s[32:35], 0 offen offset:16
    buffer_load_ushort v15, v3, s[32:35], 0 offen offset:18
    v_lshlrev_b32 v5, 3, v2
    v_and_b32 v6, 31, v2
    v_lshlrev_b32 v6, 4, v6
    s_barrier
    s_waitcnt vmcnt(8)
    s_barrier
    s_waitcnt vmcnt(0)
    v_lshl_or_b32 v8, v10, 16, v8
    v_lshl_or_b32 v9, v11, 16, v9
    v_lshlrev_b32 v12, 16, v12
    v_mul_f32 v12, 3207720526, v12
    v_lshlrev_b32 v13, 16, v13
    v_mul_f32 v13, 3207720526, v13
    v_lshlrev_b32 v14, 16, v14
    v_mul_f32 v14, 3207720526, v14
    v_lshlrev_b32 v15, 16, v15
    v_mul_f32 v15, 3207720526, v15
    buffer_store_dwordx2 v[8:9], v5, s[16:19], s47 offen sc1
    buffer_store_dwordx4 v[12:15], v6, s[16:19], s47 offen offset:512 sc1
K1_EXIT2:
    s_mov_b64 exec, 0
    s_cmp_eq_u32 s3, 7
    s_branch K2_PAD11
.p2align 12
.fill 832, 4, 0xbf810000
.globl standalone__cheap_equivariant_egnn__graph_kernel
.p2align 8
.type standalone__cheap_equivariant_egnn__graph_kernel,@function
standalone__cheap_equivariant_egnn__graph_kernel:
    s_load_dwordx2 s[12:13], s[0:1], 80
    s_load_dwordx2 s[4:5], s[0:1], 0
    s_load_dwordx2 s[8:9], s[0:1], 8
    s_load_dwordx2 s[20:21], s[0:1], 64
K2_PAD0:
    s_cbranch_execz K1_PADLINK1
    s_cmp_ge_u32 s2, 256
    s_cbranch_scc1 K2_EXIT
    v_lshrrev_b32 v1, 6, v0
    v_and_b32 v22, 63, v0
    s_and_b32 s48, s2, 7
    s_lshr_b32 s62, s2, 3
    s_lshl_b32 s48, s48, 5
    s_add_u32 s2, s48, s62
    s_mov_b32 s14, 3576832
    s_mov_b32 s15, 131072
    v_readfirstlane_b32 s3, v1
    v_lshlrev_b32 v5, 4, v22
    s_mov_b32 s37, 0
    s_mul_i32 s50, s2, 12544
    s_sub_u32 s6, 3200000, s50
    s_min_u32 s6, s6, 12544
    s_mov_b32 s7, 131072
    s_mov_b32 s10, 75008
    s_mov_b32 s11, 131072
    v_lshlrev_b32 v10, 2, v22
    v_mov_b64 v[188:189], 0
    s_mov_b32 s24, 1065307466
    s_mov_b32 s25, 1065307466
    s_mov_b32 s31, 1.0
K2_AGAIN:
    v_mov_b64 v[28:29], 0
    v_mov_b64 v[30:31], 0
    v_mov_b32 v93, 0x3f80
    s_and_b32 s69, s3, 3
    s_cmp_ge_u32 s3, 4
    s_cbranch_scc1 K2_BULK
    s_setprio 3
    s_lshl_b32 s56, s3, 12
    v_add_u32 v2, s56, v5
    ds_write_b128 v2, v[28:31] offset:56832
    ds_write_b128 v2, v[28:31] offset:57856
    v_mfma_f32_32x32x16_bf16 v[192:207], v[28:31], v[28:31], 0
    s_cmp_eq_u32 s3, 1
    s_cbranch_scc0 K2_NOSEL2
    ds_write_b128 v5, v[28:31] offset:2048
K2_NOSEL2:
    s_cmp_eq_u32 s3, 0
    s_cbranch_scc0 K2_NOROWB
    v_add_u32 v1, -1, v22
    v_lshlrev_b32 v4, 4, v1
    v_lshlrev_b32 v4, v4, v93
    v_ashrrev_i32 v2, 1, v1
    v_mov_b32 v80, 0
    v_cmp_eq_u32 s[48:49], 0, v2
    v_cmp_eq_u32 s[50:51], 1, v2
    v_cmp_eq_u32 s[52:53], 2, v2
    v_cndmask_b32 v81, 0, v4, s[48:49]
    v_cndmask_b32 v82, 0, v4, s[50:51]
    v_cndmask_b32 v83, 0, v4, s[52:53]
    ds_write_b128 v5, v[80:83] offset:0
K2_NOROWB:
    s_lshl_b32 s56, s3, 12
    s_mul_i32 s39, s3, 802816
    v_add_u32 v162, s56, v10
    v_mul_u32_u24 v160, 1568, v22
    v_cmp_eq_u32 vcc, 63, v22
    v_bfrev_b32 v2, 16
    v_mov_b64 v[84:85], 0
    v_cndmask_b32 v161, 0, v2, vcc
    v_mov_b64 v[86:87], 0
    s_lshl_b32 s57, s37, 3
    s_add_u32 s57, s57, s39
    v_mov_b32 v1, v5
    s_lshl_b32 s48, s3, 10
    s_lshr_b32 s49, s2, 2
    s_lshl_b32 s49, s49, 12
    s_add_u32 s48, s48, s49
    s_and_b32 s49, s2, 3
    s_lshl_b32 s49, s49, 2
    s_add_u32 s48, s48, s49
    s_add_u32 s48, s48, 3310592
    s_waitcnt lgkmcnt(0)
    buffer_load_dword v18, v1, s[12:15], s48 offen
    s_barrier
    s_waitcnt vmcnt(0)
    v_lshrrev_b32 v1, 16, v18
    v_add_u32_sdwa v19, v160, v18 dst_sel:DWORD dst_unused:UNUSED_PAD src0_sel:DWORD src1_sel:WORD_0
    s_nop 0
    v_add_u32_dpp v2, v1, v1 row_shr:1 row_mask:0xf bank_mask:0xf bound_ctrl:1
    s_nop 1
    v_add_u32_dpp v2, v2, v2 row_shr:2 row_mask:0xf bank_mask:0xf bound_ctrl:1
    s_nop 1
    v_add_u32_dpp v2, v2, v2 row_shr:4 row_mask:0xf bank_mask:0xf bound_ctrl:1
    s_nop 1
    v_add_u32_dpp v2, v2, v2 row_shr:8 row_mask:0xf bank_mask:0xf bound_ctrl:1
    s_nop 1
    v_add_u32_dpp v2, v2, v2 row_bcast:15 row_mask:0xa bank_mask:0xf
    s_nop 1
    v_add_u32_dpp v2, v2, v2 row_bcast:31 row_mask:0xc bank_mask:0xf
    v_sub_u32 v1, v2, v1
    v_sub_u32_e64 v3, v2, s37 clamp
    v_sub_u32 v19, v19, v1
    v_sub_u32_e64 v1, v1, s37 clamp
    v_min_u32 v3, 512, v3
    v_min_u32 v1, 512, v1
    v_lshl_add_u32 v3, v3, 2, s56
    v_lshl_add_u32 v1, v1, 2, s56
    ds_max_u32 v3, v161 offset:56832
    ds_max_u32 v1, v19 offset:56832
    ds_read2st64_b32 v[128:129], v162 offset0:222 offset1:223
    ds_read2st64_b32 v[130:131], v162 offset0:224 offset1:225
    ds_read2st64_b32 v[132:133], v162 offset0:226 offset1:227
    ds_read2st64_b32 v[134:135], v162 offset0:228 offset1:229
    v_readlane_b32 s36, v2, 63
    s_waitcnt lgkmcnt(2)
    v_max_u32_dpp v128, v128, v128 row_shr:1 row_mask:0xf bank_mask:0xf bound_ctrl:1
    v_max_u32_dpp v129, v129, v129 row_shr:1 row_mask:0xf bank_mask:0xf bound_ctrl:1
    v_max_u32_dpp v130, v130, v130 row_shr:1 row_mask:0xf bank_mask:0xf bound_ctrl:1
    v_max_u32_dpp v131, v131, v131 row_shr:1 row_mask:0xf bank_mask:0xf bound_ctrl:1
    v_max_u32_dpp v128, v128, v128 row_shr:2 row_mask:0xf bank_mask:0xf bound_ctrl:1
    v_max_u32_dpp v129, v129, v129 row_shr:2 row_mask:0xf bank_mask:0xf bound_ctrl:1
    v_max_u32_dpp v130, v130, v130 row_shr:2 row_mask:0xf bank_mask:0xf bound_ctrl:1
    v_max_u32_dpp v131, v131, v131 row_shr:2 row_mask:0xf bank_mask:0xf bound_ctrl:1
    v_max_u32_dpp v128, v128, v128 row_shr:4 row_mask:0xf bank_mask:0xf bound_ctrl:1
    v_max_u32_dpp v129, v129, v129 row_shr:4 row_mask:0xf bank_mask:0xf bound_ctrl:1
    v_max_u32_dpp v130, v130, v130 row_shr:4 row_mask:0xf bank_mask:0xf bound_ctrl:1
    v_max_u32_dpp v131, v131, v131 row_shr:4 row_mask:0xf bank_mask:0xf bound_ctrl:1
    v_max_u32_dpp v128, v128, v128 row_shr:8 row_mask:0xf bank_mask:0xf bound_ctrl:1
    v_max_u32_dpp v129, v129, v129 row_shr:8 row_mask:0xf bank_mask:0xf bound_ctrl:1
    v_max_u32_dpp v130, v130, v130 row_shr:8 row_mask:0xf bank_mask:0xf bound_ctrl:1
    v_max_u32_dpp v131, v131, v131 row_shr:8 row_mask:0xf bank_mask:0xf bound_ctrl:1
    v_max_u32_dpp v128, v128, v128 row_bcast:15 row_mask:0xa bank_mask:0xf
    v_max_u32_dpp v129, v129, v129 row_bcast:15 row_mask:0xa bank_mask:0xf
    v_max_u32_dpp v130, v130, v130 row_bcast:15 row_mask:0xa bank_mask:0xf
    v_max_u32_dpp v131, v131, v131 row_bcast:15 row_mask:0xa bank_mask:0xf
    v_max_u32_dpp v128, v128, v128 row_bcast:31 row_mask:0xc bank_mask:0xf
    v_max_u32_dpp v129, v129, v129 row_bcast:31 row_mask:0xc bank_mask:0xf
    v_max_u32_dpp v130, v130, v130 row_bcast:31 row_mask:0xc bank_mask:0xf
    v_max_u32_dpp v131, v131, v131 row_bcast:31 row_mask:0xc bank_mask:0xf
    v_readlane_b32 s48, v128, 63
    v_readlane_b32 s49, v129, 63
    v_readlane_b32 s50, v130, 63
    v_readlane_b32 s51, v131, 63
    v_add_lshl_u32 v128, v128, v22, 3
    buffer_load_dwordx2 v[136:137], v128, s[12:15], s57 offen offset:0
    v_max_u32 v129, s48, v129
    v_add_lshl_u32 v129, v129, v22, 3
    s_max_u32 s49, s49, s48
    buffer_load_dwordx2 v[138:139], v129, s[12:15], s57 offen offset:512
    v_max_u32 v130, s49, v130
    v_add_lshl_u32 v130, v130, v22, 3
    s_max_u32 s50, s50, s49
    buffer_load_dwordx2 v[140:141], v130, s[12:15], s57 offen offset:1024
    v_max_u32 v131, s50, v131
    v_add_lshl_u32 v131, v131, v22, 3
    s_max_u32 s51, s51, s50
    buffer_load_dwordx2 v[142:143], v131, s[12:15], s57 offen offset:1536
K2_PAD1:
    s_cbranch_execz K1_PADLINK2
    s_waitcnt lgkmcnt(0)
    v_max_u32_dpp v132, v132, v132 row_shr:1 row_mask:0xf bank_mask:0xf bound_ctrl:1
    v_max_u32_dpp v133, v133, v133 row_shr:1 row_mask:0xf bank_mask:0xf bound_ctrl:1
    v_max_u32_dpp v134, v134, v134 row_shr:1 row_mask:0xf bank_mask:0xf bound_ctrl:1
    v_max_u32_dpp v135, v135, v135 row_shr:1 row_mask:0xf bank_mask:0xf bound_ctrl:1
    v_max_u32_dpp v132, v132, v132 row_shr:2 row_mask:0xf bank_mask:0xf bound_ctrl:1
    v_max_u32_dpp v133, v133, v133 row_shr:2 row_mask:0xf bank_mask:0xf bound_ctrl:1
    v_max_u32_dpp v134, v134, v134 row_shr:2 row_mask:0xf bank_mask:0xf bound_ctrl:1
    v_max_u32_dpp v135, v135, v135 row_shr:2 row_mask:0xf bank_mask:0xf bound_ctrl:1
    v_max_u32_dpp v132, v132, v132 row_shr:4 row_mask:0xf bank_mask:0xf bound_ctrl:1
    v_max_u32_dpp v133, v133, v133 row_shr:4 row_mask:0xf bank_mask:0xf bound_ctrl:1
    v_max_u32_dpp v134, v134, v134 row_shr:4 row_mask:0xf bank_mask:0xf bound_ctrl:1
    v_max_u32_dpp v135, v135, v135 row_shr:4 row_mask:0xf bank_mask:0xf bound_ctrl:1
    v_max_u32_dpp v132, v132, v132 row_shr:8 row_mask:0xf bank_mask:0xf bound_ctrl:1
    v_max_u32_dpp v133, v133, v133 row_shr:8 row_mask:0xf bank_mask:0xf bound_ctrl:1
    v_max_u32_dpp v134, v134, v134 row_shr:8 row_mask:0xf bank_mask:0xf bound_ctrl:1
    v_max_u32_dpp v135, v135, v135 row_shr:8 row_mask:0xf bank_mask:0xf bound_ctrl:1
    v_max_u32_dpp v132, v132, v132 row_bcast:15 row_mask:0xa bank_mask:0xf
    v_max_u32_dpp v133, v133, v133 row_bcast:15 row_mask:0xa bank_mask:0xf
    v_max_u32_dpp v134, v134, v134 row_bcast:15 row_mask:0xa bank_mask:0xf
    v_max_u32_dpp v135, v135, v135 row_bcast:15 row_mask:0xa bank_mask:0xf
    v_max_u32_dpp v132, v132, v132 row_bcast:31 row_mask:0xc bank_mask:0xf
    v_max_u32_dpp v133, v133, v133 row_bcast:31 row_mask:0xc bank_mask:0xf
    v_max_u32_dpp v134, v134, v134 row_bcast:31 row_mask:0xc bank_mask:0xf
    v_max_u32_dpp v135, v135, v135 row_bcast:31 row_mask:0xc bank_mask:0xf
    v_readlane_b32 s52, v132, 63
    v_readlane_b32 s53, v133, 63
    v_readlane_b32 s54, v134, 63
    v_max_u32 v132, s51, v132
    v_add_lshl_u32 v132, v132, v22, 3
    s_max_u32 s52, s52, s51
    buffer_load_dwordx2 v[144:145], v132, s[12:15], s57 offen offset:2048
    v_max_u32 v133, s52, v133
    v_add_lshl_u32 v133, v133, v22, 3
    s_max_u32 s53, s53, s52
    buffer_load_dwordx2 v[146:147], v133, s[12:15], s57 offen offset:2560
    v_max_u32 v134, s53, v134
    v_add_lshl_u32 v134, v134, v22, 3
    s_max_u32 s54, s54, s53
    buffer_load_dwordx2 v[148:149], v134, s[12:15], s57 offen offset:3072
    v_max_u32 v135, s54, v135
    v_add_lshl_u32 v135, v135, v22, 3
    buffer_load_dwordx2 v[150:151], v135, s[12:15], s57 offen offset:3584
K2_CONST:
    s_mov_b32 s64, 256
    s_lshr_b32 s48, s3, 2
    s_lshl_b32 s26, s69, 1
    s_add_u32 s26, s26, s48
    s_mul_i32 s27, s3, 784
    s_add_u32 s27, s27, 45472
    s_cmp_lt_u32 s3, 4
    s_cselect_b32 s28, 0, 3
    s_mov_b32 s29, 0x0000bf80
    s_mov_b32 s30, 0xbf800000
    s_mov_b32 s32, 79616
    s_add_u32 s48, s27, 111968
    v_add_u32 v1, s48, v5
    ds_write_b128 v1, v[28:31]
    v_lshrrev_b32 v1, 5, v22
    v_bfe_u32 v2, v22, 1, 1
    v_lshlrev_b32 v17, 5, v1
    v_lshl_or_b32 v17, v2, 4, v17
    v_bfe_u32 v3, v22, 2, 3
    v_and_b32 v4, 1, v22
    v_lshl_or_b32 v3, v3, 1, v4
    s_mov_b32 s48, 33792
    v_lshl_add_u32 v14, v3, 3, s48
    v_xor_b32 v2, v2, v1
    v_lshl_or_b32 v15, v2, 24, v14
    v_bfe_u32 v2, v22, 3, 1
    v_bfe_u32 v3, v22, 2, 1
    v_lshl_or_b32 v3, v2, 2, v3
    v_lshl_or_b32 v3, v1, 3, v3
    v_bfe_u32 v2, v22, 4, 1
    v_lshl_or_b32 v3, v2, 1, v3
    v_lshl_add_u32 v13, v3, 3, s48
    s_mov_b32 s48, 0x181f181e
    v_lshlrev_b32 v3, 3, v22
    v_lshrrev_b32_e64 v3, v3, s48
    v_lshlrev_b32 v12, v3, 1
    v_mov_b32 v9, 0xdddddddd
    v_and_b32 v2, 31, v22
    v_lshlrev_b32 v3, 3, v2
    v_add_u32 v8, 111968, v3
    v_lshlrev_b32 v3, 3, v1
    v_sub_u32 v2, v2, v3
    v_lshlrev_b32 v4, 4, v2
    v_lshlrev_b32 v4, v4, v93
    v_ashrrev_i32 v2, 1, v2
    v_cmp_eq_u32 s[48:49], 0, v2
    v_cmp_eq_u32 s[50:51], 1, v2
    v_cmp_eq_u32 s[52:53], 2, v2
    v_cmp_eq_u32 s[54:55], 3, v2
    v_cndmask_b32 v32, 0, v4, s[48:49]
    v_cndmask_b32 v33, 0, v4, s[50:51]
    v_cndmask_b32 v34, 0, v4, s[52:53]
    v_cndmask_b32 v35, 0, v4, s[54:55]
    v_cmp_eq_u32 s[48:49], 8, v2
    v_cmp_eq_u32 s[50:51], 9, v2
    v_cmp_eq_u32 s[52:53], 10, v2
    v_cmp_eq_u32 s[54:55], 11, v2
    v_cndmask_b32 v36, 0, v4, s[48:49]
    v_cndmask_b32 v37, 0, v4, s[50:51]
    v_cndmask_b32 v38, 0, v4, s[52:53]
    v_cndmask_b32 v39, 0, v4, s[54:55]
    v_mov_b64 v[64:65], 0
    v_mov_b64 v[66:67], 0
    v_mov_b64 v[68:69], 0
    v_mov_b64 v[70:71], 0
    v_mov_b64 v[72:73], 0
    v_mov_b64 v[74:75], 0
    v_mov_b64 v[76:77], 0
    v_mov_b64 v[78:79], 0
K2_PAD2:
    s_cbranch_execz K1_PADLINK3
    v_add_u32 v1, -1, v22
    v_cmp_gt_u32 vcc, 49, v1
    v_mov_b32 v2, 0x01002000
    v_lshlrev_b32_e64 v91, 2, s3
    v_cndmask_b32_e64 v88, 0, 16, vcc
    v_cndmask_b32_e64 v89, 0, -1, vcc
    v_cndmask_b32_e64 v90, v2, 0, vcc
    v_mov_b32 v92, 1
    v_bfe_u32 v2, v1, 1, 5
    v_mul_u32_u24 v3, 43, v2
    v_lshrrev_b32 v3, 7, v3
    v_mad_i32_i24 v4, v3, -3, v2
    v_lshlrev_b32 v0, 3, v4
    s_mov_b32 s48, 0x630300
    v_bfe_u32 v0, s48, v0, 8
    v_lshl_or_b32 v0, v4, 20, v0
    v_lshl_or_b32 v0, v2, 15, v0
    s_mov_b32 s48, 3171
    v_mad_u32_u24 v0, v3, s48, v0
    v_add_u32 v6, 2080, v0
    v_lshl_add_u32 v94, v2, 3, 28
    s_cmp_ge_u32 s3, 4
    s_cbranch_scc1 K2_BULK2
    s_add_u32 s16, s12, 4194304
    s_addc_u32 s17, s13, 0
    s_or_b32 s17, s17, 16777216
    s_mov_b32 s18, 12500
    s_mov_b32 s19, 131072
    v_add_u32_e64 v163, s36, 1
    v_mov_b32 v166, 0xff00ffff
    v_mov_b32 v167, 252
    s_add_u32 s56, s37, 513
    v_lshlrev_b32 v164, 1, v10
    v_and_b32 v165, 496, v5
    s_waitcnt vmcnt(7)
    v_and_b32 v152, 0xff, v137
    ds_add_rtn_u32 v80, v152, v92 offset:256
    s_waitcnt vmcnt(6)
    v_and_b32 v153, 0xff, v139
    ds_add_rtn_u32 v81, v153, v92 offset:256
    s_waitcnt vmcnt(5)
    v_and_b32 v154, 0xff, v141
    ds_add_rtn_u32 v82, v154, v92 offset:256
    s_waitcnt vmcnt(4)
    v_and_b32 v155, 0xff, v143
    ds_add_rtn_u32 v83, v155, v92 offset:256
    s_waitcnt vmcnt(3)
    v_and_b32 v156, 0xff, v145
    ds_add_rtn_u32 v84, v156, v92 offset:256
    s_waitcnt vmcnt(0)
    v_and_b32 v157, 0xff, v147
    v_and_b32 v158, 0xff, v149
    v_and_b32 v159, 0xff, v151
    v_cmpx_ne_u32 vcc, 0, v157
    ds_add_rtn_u32 v85, v157, v92 offset:256
    v_cmpx_ne_u32 vcc, 0, v158
    ds_add_rtn_u32 v86, v158, v92 offset:256
    v_cmpx_ne_u32 vcc, 0, v159
    ds_add_rtn_u32 v87, v159, v92 offset:256
    s_mov_b64 exec, -1
    ds_write_b32 v91, v163 offset:480
K2_POLL:
    ds_read_b32 v3, v10 offset:256
    s_waitcnt lgkmcnt(0)
    v_cmp_ne_u32 vcc, 0, v3
    v_med3_u32 v4, v3, v88, v89
    v_cmp_lt_u32 s[54:55], s56, v3
    s_nop 0
    v_add_u32_dpp v2, v4, v4 row_shr:1 row_mask:0xf bank_mask:0xf bound_ctrl:1
    v_sub_u32 v4, v4, v90
    s_lshr_b32 s48, vcc_hi, 24
    v_add_u32_dpp v2, v2, v2 row_shr:2 row_mask:0xf bank_mask:0xf bound_ctrl:1
    s_cmp_eq_u32 s48, 15
    s_cbranch_scc0 K2_POLL
    v_add_u32_dpp v2, v2, v2 row_shr:4 row_mask:0xf bank_mask:0xf bound_ctrl:1
    s_lshr_b32 s34, s55, 24
    s_nop 0
    v_add_u32_dpp v2, v2, v2 row_shr:8 row_mask:0xf bank_mask:0xf bound_ctrl:1
    s_nop 1
    v_add_u32_dpp v2, v2, v2 row_bcast:15 row_mask:0xa bank_mask:0xf
    s_nop 1
    v_add_u32_dpp v2, v2, v2 row_bcast:31 row_mask:0xc bank_mask:0xf
    v_sub_u32 v11, v2, v4
    ds_write_b32 v10, v11 offset:768
    ds_read_b32 v128, v152 offset:768
    ds_read_b32 v129, v153 offset:768
    ds_read_b32 v130, v154 offset:768
    ds_read_b32 v131, v155 offset:768
    ds_read_b32 v132, v156 offset:768
    ds_read_b32 v133, v157 offset:768
    ds_read_b32 v134, v158 offset:768
    ds_read_b32 v135, v159 offset:768
    ds_read_b32 v94, v94 offset:768
    v_readlane_b32 s48, v2, 63
    v_cmp_lt_u32 vcc, v3, v88
    s_waitcnt lgkmcnt(8)
    v_add_lshl_u32 v128, v128, v80, 3
    ds_write_b64 v128, v[136:137] offset:33792
    s_waitcnt lgkmcnt(8)
    v_add_lshl_u32 v129, v129, v81, 3
    ds_write_b64 v129, v[138:139] offset:33792
    s_waitcnt lgkmcnt(8)
    v_add_lshl_u32 v130, v130, v82, 3
    ds_write_b64 v130, v[140:141] offset:33792
    s_waitcnt lgkmcnt(8)
    v_add_lshl_u32 v131, v131, v83, 3
    ds_write_b64 v131, v[142:143] offset:33792
    s_waitcnt lgkmcnt(8)
    v_add_lshl_u32 v132, v132, v84, 3
    ds_write_b64 v132, v[144:145] offset:33792
    s_waitcnt lgkmcnt(8)
    v_add_lshl_u32 v133, v133, v85, 3
    ds_write_b64 v133, v[146:147] offset:33792
    s_waitcnt lgkmcnt(8)
    v_add_lshl_u32 v134, v134, v86, 3
    ds_write_b64 v134, v[148:149] offset:33792
    s_waitcnt lgkmcnt(8)
    v_add_lshl_u32 v135, v135, v87, 3
    ds_write_b64 v135, v[150:151] offset:33792
    v_add_lshl_u32 v4, s48, v22, 3
    ds_write_b64 v4, v[166:167] offset:33792
    s_cbranch_vccnz K2_FILL
K2_FILLED:
    s_add_u32 s49, s48, 15
    s_lshr_b32 s49, s49, 4
    s_mul_i32 s40, s49, s26
    s_add_u32 s41, s40, s49
    s_lshr_b32 s40, s40, 3
    s_lshr_b32 s41, s41, 3
    s_lshl_b32 s56, s40, 7
    v_add_u32 v14, s56, v14
    v_add_u32 v15, s56, v15
    v_add_u32 v13, s56, v13
    v_lshl_add_u32 v0, v22, 3, s56
    s_waitcnt lgkmcnt(0)
    s_barrier
    ds_read_u16 v16, v14
    ds_read_u16 v210, v14 offset:128
    v_mov_b32 v211, v17
    ds_read_u8 v48, v15 offset:2
    ds_read_u8 v52, v15 offset:130
    ds_read2_b32 v[218:219], v13 offset0:32 offset1:0
    s_waitcnt lgkmcnt(4)
    buffer_load_dwordx4 v[96:99], v[16:17], s[16:19], 0 idxen offen offset:0
    buffer_load_dwordx4 v[100:103], v[16:17], s[16:19], 0 idxen offen offset:64
    buffer_load_dwordx4 v[104:107], v[16:17], s[16:19], 0 idxen offen offset:128
    buffer_load_dwordx4 v[108:111], v[16:17], s[16:19], 0 idxen offen offset:192
    s_waitcnt lgkmcnt(1)
    buffer_load_dwordx4 v[112:115], v[210:211], s[16:19], 0 idxen offen offset:0
    buffer_load_dwordx4 v[116:119], v[210:211], s[16:19], 0 idxen offen offset:64
    buffer_load_dwordx4 v[120:123], v[210:211], s[16:19], 0 idxen offen offset:128
    buffer_load_dwordx4 v[124:127], v[210:211], s[16:19], 0 idxen offen offset:192
    ds_read_b128 v[48:51], v48 offset:0
    ds_read_b128 v[52:55], v52 offset:0
    ds_read_u16 v16, v14 offset:256
    ds_read_u8 v216, v15 offset:258
    ds_read_u16 v210, v14 offset:384
    ds_read_b32 v40, v164 offset:4096
    ds_read_b32 v44, v164 offset:4100
    ds_read_b128 v[24:27], v165 offset:4608
K2_PAD3:
    s_cbranch_execz K1_PADLINK4
K2_SETUP:
    v_lshrrev_b32 v94, 4, v94
    v_lshl_or_b32 v6, v94, 22, v6
    s_lshl_b32 s59, s41, 4
    v_cmp_gt_u32 vcc, s59, v11
    v_add_u32 v208, 15, v11
    s_bcnt1_i32_b64 s65, vcc
    s_add_u32 s65, s65, 1
    v_lshrrev_b32 v208, 4, v208
    s_lshl_b32 s58, s40, 4
    v_cmp_ge_u32 vcc, s58, v11
    s_bcnt1_i32_b64 s57, vcc
    v_readlane_b32 s48, v6, s57
    s_bfe_u32 s52, s48, 327680
    v_lshl_add_u32 v1, s52, 9, v10
    ds_read_b32 v41, v1 offset:5120
    ds_read_b32 v45, v1 offset:5376
    s_bfe_u32 s52, s48, 327685
    v_lshl_add_u32 v2, s52, 9, v10
    ds_read_b32 v42, v2 offset:5120
    ds_read_b32 v46, v2 offset:5376
    s_bfe_u32 s52, s48, 327690
    v_lshl_add_u32 v3, s52, 9, v10
    ds_read_b32 v43, v3 offset:5120
    ds_read_b32 v47, v3 offset:5376
    s_lshr_b32 s43, s48, 22
    v_readlane_b32 s50, v11, s57
    v_lshlrev_b32_e64 v4, 3, s57
    s_add_u32 s46, s57, 1
    s_mul_i32 s51, s46, 784
    v_mov_b32 v217, 784
    v_add_lshl_u32 v5, v4, s3, 1
    ds_write_b32 v91, v4 offset:512
    ds_write_b16 v5, v93 offset:2032
    v_readlane_b32 s44, v208, s46
    s_bitcmp1_b32 s57, 0
    s_cselect_b32 s96, 0, -1
    s_cselect_b32 s97, -1, 0
    s_cmp_lt_u32 s50, s58
    s_cselect_b32 s63, s27, s51
    v_add_u32 v7, s63, v8
    s_addc_u32 s52, s46, 0
    v_readlane_b32 s33, v208, s52
    v_mov_b32_dpp v209, v12 quad_perm:[1,0,3,2] row_mask:0xf bank_mask:0xf
    s_sub_u32 s47, s43, 1
    s_sub_i32 s38, s41, s28
    s_max_i32 s38, s38, s40
    s_sub_u32 s41, s41, 1
    s_sub_u32 s33, s33, 1
    s_min_u32 s47, s47, s38
    s_min_u32 s47, s47, s41
    s_min_u32 s47, s47, s33
    s_min_u32 s42, s47, s44
    s_sub_u32 s40, s42, s40
    s_sub_u32 s59, s59, s58
K2_ST2:
    ds_read_b32 v1, v10 offset:560
    ds_read_b64 v[134:135], v0 offset:35328
    ds_read_b64 v[128:129], v0 offset:33792
    ds_read_b64 v[130:131], v0 offset:34304
    ds_read_b64 v[132:133], v0 offset:34816
    s_sub_i32 s49, s59, 64
    s_sub_i32 s50, s59, 128
    s_sub_i32 s51, s59, 192
    s_waitcnt lgkmcnt(4)
    v_cmp_eq_u32 vcc, v1, v93
    s_cmp_eq_u32 vcc_lo, 0xf0
    s_cbranch_scc0 K2_ST2
    v_cmpx_gt_i32 vcc, s51, v22
    s_cbranch_execz K2_SKIP3A
    s_waitcnt lgkmcnt(3)
    v_mad_u32_u16 v83, v134, 6, s32
    v_lshlrev_b32_sdwa v2, 2, v135 dst_sel:DWORD dst_unused:UNUSED_PAD src0_sel:DWORD src1_sel:BYTE_0
    v_and_b32 v1, -4, v83
    ds_read_b128 v[156:159], v2 offset:1008
    ds_read2_b32 v[142:143], v1 offset0:0 offset1:1
K2_SKIP3A:
    s_mov_b64 exec, -1
    s_waitcnt lgkmcnt(2)
    v_mad_u32_u16 v80, v128, 6, s32
    v_lshlrev_b32_sdwa v2, 2, v129 dst_sel:DWORD dst_unused:UNUSED_PAD src0_sel:DWORD src1_sel:BYTE_0
    v_and_b32 v1, -4, v80
    ds_read_b128 v[144:147], v2 offset:1008
    ds_read2_b32 v[136:137], v1 offset0:0 offset1:1
    s_waitcnt lgkmcnt(3)
    v_mad_u32_u16 v81, v130, 6, s32
    v_lshlrev_b32_sdwa v2, 2, v131 dst_sel:DWORD dst_unused:UNUSED_PAD src0_sel:DWORD src1_sel:BYTE_0
    v_and_b32 v1, -4, v81
    ds_read_b128 v[148:151], v2 offset:1008
    ds_read2_b32 v[138:139], v1 offset0:0 offset1:1
    s_waitcnt lgkmcnt(4)
    v_mad_u32_u16 v82, v132, 6, s32
    v_lshlrev_b32_sdwa v2, 2, v133 dst_sel:DWORD dst_unused:UNUSED_PAD src0_sel:DWORD src1_sel:BYTE_0
    v_and_b32 v1, -4, v82
    ds_read_b128 v[152:155], v2 offset:1008
    ds_read2_b32 v[140:141], v1 offset0:0 offset1:1
    s_waitcnt lgkmcnt(4)
    v_alignbyte_b32 v136, v137, v136, v80
    s_waitcnt lgkmcnt(2)
    v_alignbyte_b32 v138, v139, v138, v81
    s_waitcnt lgkmcnt(0)
    v_alignbyte_b32 v140, v141, v140, v82
    v_alignbyte_b32 v137, v137, v137, v80
    v_alignbyte_b32 v139, v139, v139, v81
    v_alignbyte_b32 v141, v141, v141, v82
    v_dot2c_f32_bf16 v144, s29, v136
    v_dot2c_f32_bf16 v148, s29, v138
    v_dot2c_f32_bf16 v152, s29, v140
    v_dot2c_f32_bf16 v145, s30, v136
    v_dot2c_f32_bf16 v149, s30, v138
    v_dot2c_f32_bf16 v153, s30, v140
    v_dot2c_f32_bf16 v146, s29, v137
    v_dot2c_f32_bf16 v150, s29, v139
    v_dot2c_f32_bf16 v154, s29, v141
    v_cvt_pk_bf16_f32 v136, s31, v144
    v_cvt_pk_bf16_f32 v138, s31, v148
    v_cvt_pk_bf16_f32 v140, s31, v152
    v_cvt_pk_bf16_f32 v137, v145, v146
    v_cvt_pk_bf16_f32 v139, v149, v150
    v_cvt_pk_bf16_f32 v141, v153, v154
    v_mul_f32 v147, v144, v144
    v_mul_f32 v151, v148, v148
    v_mul_f32 v155, v152, v152
    v_fmac_f32 v147, v145, v145
    v_fmac_f32 v151, v149, v149
    v_fmac_f32 v155, v153, v153
    v_fmac_f32 v147, v146, v146
    v_fmac_f32 v151, v150, v150
    v_fmac_f32 v155, v154, v154
    v_mul_f32 v147, 3216550459, v147
    v_mul_f32 v151, 3216550459, v151
    v_mul_f32 v155, 3216550459, v155
    v_cvt_pk_bf16_f32 v129, v147, v129
    v_cvt_pk_bf16_f32 v131, v151, v131
    v_cvt_pk_bf16_f32 v133, v155, v133
    v_cmpx_gt_i32 vcc, s59, v22
    ds_write_b64 v0, v[136:137] offset:56832
    ds_write_b32 v0, v129 offset:33796
    v_cmpx_gt_i32 vcc, s49, v22
    ds_write_b64 v0, v[138:139] offset:57344
    ds_write_b32 v0, v131 offset:34308
    v_cmpx_gt_i32 vcc, s50, v22
    ds_write_b64 v0, v[140:141] offset:57856
    ds_write_b32 v0, v133 offset:34820
    v_cmpx_gt_i32 vcc, s51, v22
    s_cbranch_execz K2_SKIP3B
    v_alignbyte_b32 v142, v143, v142, v83
    v_alignbyte_b32 v143, v143, v143, v83
    v_dot2c_f32_bf16 v156, s29, v142
    v_dot2c_f32_bf16 v157, s30, v142
    v_dot2c_f32_bf16 v158, s29, v143
    s_nop 0
    v_cvt_pk_bf16_f32 v142, s31, v156
    s_nop 0
    v_cvt_pk_bf16_f32 v143, v157, v158
    v_mul_f32 v159, v156, v156
    v_fmac_f32 v159, v157, v157
    v_fmac_f32 v159, v158, v158
    v_mul_f32 v159, 3216550459, v159
    v_cvt_pk_bf16_f32 v135, v159, v135
    ds_write_b64 v0, v[142:143] offset:58368
    ds_write_b32 v0, v135 offset:35332
    s_mov_b64 exec, -1
    v_add_u32 v0, 2048, v0
    s_sub_i32 s59, s59, 256
    s_cmp_gt_i32 s59, 0
    s_cbranch_scc1 K2_ST2
K2_SKIP3B:
    s_mov_b64 exec, -1
    ds_read_b32 v48, v15 offset:4
    ds_read_b32 v52, v15 offset:132
    ds_write_b32 v91, v92 offset:640
K2_PAD4:
    s_cbranch_execz K1_PADEND
    s_cmp_lt_u32 s3, 4
    s_cbranch_scc1 K2_NOG1
    buffer_load_dwordx4 v[112:115], v[210:211], s[16:19], 0 idxen offen offset:0
    buffer_load_dwordx4 v[116:119], v[210:211], s[16:19], 0 idxen offen offset:64
    buffer_load_dwordx4 v[120:123], v[210:211], s[16:19], 0 idxen offen offset:128
    buffer_load_dwordx4 v[124:127], v[210:211], s[16:19], 0 idxen offen offset:192
    ds_read_u16 v210, v14 offset:384
K2_NOG1:
    s_cmp_lt_u32 s3, 4
    s_cbranch_scc0 K2_PRIO
    s_setprio 1
K2_PRIO:
    v_mov_b64 v[0:1], s[24:25]
    v_mov_b64 v[186:187], 0
    v_and_or_b32 v2, v219, v12, v13
    v_and_or_b32 v3, v219, v209, v13
    v_and_or_b32 v18, v218, v12, v13
    v_and_or_b32 v19, v218, v209, v13
    s_waitcnt vmcnt(4) lgkmcnt(0)
    v_mfma_f32_32x32x16_bf16 v[128:143], v[96:99], v[32:35], 0
    v_mfma_f32_32x32x16_bf16 v[128:143], v[100:103], v[36:39], v[128:143]
    v_mfma_f32_32x32x16_bf16 v[128:143], v[48:51], v[40:43], v[128:143]
    ds_read_b64_tr_b16 v[212:213], v2 offset:23040
    ds_read_b64_tr_b16 v[214:215], v3 offset:23040
    ds_read_b32 v219, v13 offset:256
    s_cmp_lg_u32 s31, 1.0
    s_cbranch_scc1 K2S_ENTER
    s_nop 4
    s_branch K2_LOOP
.p2align 3
K2_EVT0:
    s_cmp_lg_u32 s44, s42
    s_cbranch_scc1 K2_OTH0
    s_not_b64 exec, s[96:97]
    s_add_u32 s46, s46, 1
    v_readlane_b32 s44, v208, s46
    v_pk_mul_f32 v[2:3], v[192:193], v[24:25] op_sel:[0,0] op_sel_hi:[1,0]
    v_pk_mul_f32 v[4:5], v[194:195], v[24:25] op_sel:[0,0] op_sel_hi:[1,0]
    v_cvt_pk_bf16_f32 v0, v192, v196
    v_pk_fma_f32 v[2:3], v[196:197], v[24:25], v[2:3] op_sel:[0,1,0] op_sel_hi:[1,1,1]
    v_pk_fma_f32 v[4:5], v[198:199], v[24:25], v[4:5] op_sel:[0,1,0] op_sel_hi:[1,1,1]
    v_cvt_pk_bf16_f32 v1, v200, v204
    v_pk_fma_f32 v[2:3], v[200:201], v[26:27], v[2:3] op_sel:[0,0,0] op_sel_hi:[1,0,1]
    v_pk_fma_f32 v[4:5], v[202:203], v[26:27], v[4:5] op_sel:[0,0,0] op_sel_hi:[1,0,1]
    v_pk_fma_f32 v[2:3], v[204:205], v[26:27], v[2:3] op_sel:[0,1,0] op_sel_hi:[1,1,1]
    v_pk_fma_f32 v[4:5], v[206:207], v[26:27], v[4:5] op_sel:[0,1,0] op_sel_hi:[1,1,1]
    ds_read_b128 v[192:195], v12
    ds_read_b128 v[196:199], v12
    ds_read_b128 v[200:203], v12
    ds_read_b128 v[204:207], v12
    ds_write_b64 v7, v[0:1]
    ds_write2_b64 v7, v[2:3], v[4:5] offset0:32 offset1:64
    s_or_saveexec_b64 s[96:97], -1
    s_not_b32 s40, s42
    v_mad_u32_u24 v7, s46, v217, v8
    s_min_u32 s42, s44, s47
    s_add_u32 s40, s40, s42
    s_cbranch_scc1 K2_RET0
K2_OTH0:
    s_cmp_eq_u32 s41, s42
    s_cbranch_scc1 K2_LAST0
    s_mov_b32 s35, 0
    s_branch K2_OTH
.p2align 3
K2_EVT1:
    s_cmp_lg_u32 s44, s42
    s_cbranch_scc1 K2_OTH1
    s_not_b64 exec, s[96:97]
    s_add_u32 s46, s46, 1
    v_readlane_b32 s44, v208, s46
    v_pk_mul_f32 v[2:3], v[192:193], v[24:25] op_sel:[0,0] op_sel_hi:[1,0]
    v_pk_mul_f32 v[4:5], v[194:195], v[24:25] op_sel:[0,0] op_sel_hi:[1,0]
    v_cvt_pk_bf16_f32 v0, v192, v196
    v_pk_fma_f32 v[2:3], v[196:197], v[24:25], v[2:3] op_sel:[0,1,0] op_sel_hi:[1,1,1]
    v_pk_fma_f32 v[4:5], v[198:199], v[24:25], v[4:5] op_sel:[0,1,0] op_sel_hi:[1,1,1]
    v_cvt_pk_bf16_f32 v1, v200, v204
    v_pk_fma_f32 v[2:3], v[200:201], v[26:27], v[2:3] op_sel:[0,0,0] op_sel_hi:[1,0,1]
    v_pk_fma_f32 v[4:5], v[202:203], v[26:27], v[4:5] op_sel:[0,0,0] op_sel_hi:[1,0,1]
    v_pk_fma_f32 v[2:3], v[204:205], v[26:27], v[2:3] op_sel:[0,1,0] op_sel_hi:[1,1,1]
    v_pk_fma_f32 v[4:5], v[206:207], v[26:27], v[4:5] op_sel:[0,1,0] op_sel_hi:[1,1,1]
    ds_read_b128 v[192:195], v12
    ds_read_b128 v[196:199], v12
    ds_read_b128 v[200:203], v12
    ds_read_b128 v[204:207], v12
    ds_write_b64 v7, v[0:1]
    ds_write2_b64 v7, v[2:3], v[4:5] offset0:32 offset1:64
    s_or_saveexec_b64 s[96:97], -1
    s_not_b32 s40, s42
    v_mad_u32_u24 v7, s46, v217, v8
    s_min_u32 s42, s44, s47
    s_add_u32 s40, s40, s42
    s_cbranch_scc1 K2_RET1
K2_OTH1:
    s_cmp_eq_u32 s41, s42
    s_cbranch_scc1 K2_LAST1
    s_mov_b32 s35, 1
    s_branch K2_OTH
K2_BEND:
.p2align 12
K2_PAD5:
    s_branch K1_PADLINK6
.p2align 3
K2_LOOP:
    v_mfma_f32_32x32x16_bf16 v[144:159], v[104:107], v[32:35], 0
    v_exp_f32 v80, v128
    v_exp_f32 v81, v129
    v_exp_f32_e64 v82, v130
    v_mfma_f32_32x32x16_bf16 v[144:159], v[108:111], v[36:39], v[144:159]
    v_exp_f32 v83, v131
    v_exp_f32 v84, v132
    v_exp_f32_e64 v85, v133
    v_mfma_f32_32x32x16_bf16 v[144:159], v[48:51], v[44:47], v[144:159]
    v_exp_f32 v86, v134
    v_exp_f32 v87, v135
    v_exp_f32_e64 v88, v136
    v_smfmac_f32_16x16x64_bf16 v[200:203], v[28:31], v[64:71], v9
    v_exp_f32 v89, v137
    v_exp_f32 v90, v138
    v_exp_f32_e64 v91, v139
    v_smfmac_f32_16x16x64_bf16 v[204:207], v[28:31], v[72:79], v9
    v_exp_f32 v92, v140
    v_exp_f32 v93, v141
    v_exp_f32 v94, v142
    v_exp_f32 v95, v143
    v_pk_add_f32 v[56:57], v[82:83], 1.0 op_sel_hi:[1,0]
    v_pk_fma_f32 v[58:59], v[56:57], v[80:81], v[56:57]
    v_pk_mul_f32 v[128:129], v[128:129], v[56:57]
    v_pk_fma_f32 v[56:57], v[58:59], v[84:85], v[58:59]
    v_pk_mul_f32 v[132:133], v[132:133], v[58:59]
    v_pk_fma_f32 v[58:59], v[56:57], v[86:87], v[56:57]
    v_pk_mul_f32 v[134:135], v[134:135], v[56:57]
    v_pk_fma_f32 v[56:57], v[58:59], v[88:89], v[58:59]
    v_pk_mul_f32 v[136:137], v[136:137], v[58:59]
    v_pk_fma_f32 v[58:59], v[56:57], v[90:91], v[56:57]
    v_pk_mul_f32 v[138:139], v[138:139], v[56:57]
    v_pk_fma_f32 v[56:57], v[58:59], v[92:93], v[58:59]
    v_pk_mul_f32 v[140:141], v[140:141], v[58:59]
    v_pk_fma_f32 v[2:3], v[56:57], v[94:95], v[56:57]
    v_rcp_f32 v4, v2
    v_rcp_f32 v5, v3
    v_pk_fma_f32 v[186:187], v[0:1], v[2:3], v[186:187]
    v_pk_mul_f32 v[142:143], v[142:143], v[56:57]
    v_pk_fma_f32 v[20:21], v[4:5], v[94:95], v[4:5]
    v_pk_mul_f32 v[78:79], v[142:143], v[4:5]
    v_pk_fma_f32 v[22:23], v[20:21], v[92:93], v[20:21]
    v_pk_mul_f32 v[70:71], v[140:141], v[20:21]
    v_pk_fma_f32 v[20:21], v[22:23], v[90:91], v[22:23]
    v_pk_mul_f32 v[76:77], v[138:139], v[22:23]
    v_pk_fma_f32 v[22:23], v[20:21], v[88:89], v[20:21]
    v_pk_mul_f32 v[68:69], v[136:137], v[20:21]
    v_pk_fma_f32 v[20:21], v[22:23], v[86:87], v[22:23]
    v_pk_mul_f32 v[74:75], v[134:135], v[22:23]
    v_pk_fma_f32 v[22:23], v[20:21], v[84:85], v[20:21]
    v_pk_mul_f32 v[66:67], v[132:133], v[20:21]
    v_pk_fma_f32 v[20:21], v[22:23], v[80:81], v[22:23]
    v_pk_mul_f32 v[64:65], v[128:129], v[22:23]
    v_pk_mul_f32 v[72:73], v[130:131], v[20:21]
    v_add_u32 v14, s64, v14
    s_sub_u32 s40, s40, 1
    s_cbranch_scc1 K2_EVT0
K2_RET0:
    s_waitcnt vmcnt(0) lgkmcnt(0)
    buffer_load_dwordx4 v[96:99], v[16:17], s[16:19], 0 idxen offen offset:0
    buffer_load_dwordx4 v[100:103], v[16:17], s[16:19], 0 idxen offen offset:64
    buffer_load_dwordx4 v[104:107], v[16:17], s[16:19], 0 idxen offen offset:128
    buffer_load_dwordx4 v[108:111], v[16:17], s[16:19], 0 idxen offen offset:192
    ds_read_b128 v[48:51], v216 offset:0
    ds_read_b32 v48, v15 offset:260
    ds_read_u8 v216, v15 offset:386
    ds_read_u16 v16, v14 offset:256
    ds_read_b64_tr_b16 v[28:29], v18 offset:23168
    ds_read_b64_tr_b16 v[30:31], v19 offset:23168
    ds_read_b32 v218, v13 offset:384
    v_mfma_f32_32x32x16_bf16 v[128:143], v[112:115], v[32:35], 0
    v_exp_f32 v80, v144
    v_exp_f32 v81, v145
    v_exp_f32_e64 v82, v146
    v_mfma_f32_32x32x16_bf16 v[128:143], v[116:119], v[36:39], v[128:143]
    v_exp_f32 v83, v147
    v_exp_f32 v84, v148
    v_exp_f32_e64 v85, v149
    v_mfma_f32_32x32x16_bf16 v[128:143], v[52:55], v[40:43], v[128:143]
    v_exp_f32 v86, v150
    v_exp_f32 v87, v151
    v_exp_f32_e64 v88, v152
    v_smfmac_f32_16x16x64_bf16 v[192:195], v[212:215], v[64:71], v9
    v_exp_f32 v89, v153
    v_exp_f32 v90, v154
    v_exp_f32_e64 v91, v155
    v_smfmac_f32_16x16x64_bf16 v[196:199], v[212:215], v[72:79], v9
    v_exp_f32 v92, v156
    v_exp_f32 v93, v157
    v_exp_f32 v94, v158
    v_exp_f32 v95, v159
    v_pk_add_f32 v[56:57], v[82:83], 1.0 op_sel_hi:[1,0]
    v_pk_fma_f32 v[58:59], v[56:57], v[80:81], v[56:57]
    v_pk_mul_f32 v[144:145], v[144:145], v[56:57]
    v_pk_fma_f32 v[56:57], v[58:59], v[84:85], v[58:59]
    v_pk_mul_f32 v[148:149], v[148:149], v[58:59]
    v_pk_fma_f32 v[58:59], v[56:57], v[86:87], v[56:57]
    v_pk_mul_f32 v[150:151], v[150:151], v[56:57]
    v_pk_fma_f32 v[56:57], v[58:59], v[88:89], v[58:59]
    v_pk_mul_f32 v[152:153], v[152:153], v[58:59]
    v_pk_fma_f32 v[58:59], v[56:57], v[90:91], v[56:57]
    v_pk_mul_f32 v[154:155], v[154:155], v[56:57]
    v_pk_fma_f32 v[56:57], v[58:59], v[92:93], v[58:59]
    v_pk_mul_f32 v[156:157], v[156:157], v[58:59]
    v_pk_fma_f32 v[0:1], v[56:57], v[94:95], v[56:57]
    v_rcp_f32 v4, v0
    v_rcp_f32 v5, v1
    v_and_or_b32 v18, v219, v12, v13
    v_and_or_b32 v19, v219, v209, v13
    v_pk_mul_f32 v[158:159], v[158:159], v[56:57]
    v_pk_fma_f32 v[20:21], v[4:5], v[94:95], v[4:5]
    v_pk_mul_f32 v[78:79], v[158:159], v[4:5]
    v_pk_fma_f32 v[22:23], v[20:21], v[92:93], v[20:21]
    v_pk_mul_f32 v[70:71], v[156:157], v[20:21]
    v_pk_fma_f32 v[20:21], v[22:23], v[90:91], v[22:23]
    v_pk_mul_f32 v[76:77], v[154:155], v[22:23]
    v_pk_fma_f32 v[22:23], v[20:21], v[88:89], v[20:21]
    v_pk_mul_f32 v[68:69], v[152:153], v[20:21]
    v_pk_fma_f32 v[20:21], v[22:23], v[86:87], v[22:23]
    v_pk_mul_f32 v[74:75], v[150:151], v[22:23]
    v_pk_fma_f32 v[22:23], v[20:21], v[84:85], v[20:21]
    v_pk_mul_f32 v[66:67], v[148:149], v[20:21]
    v_pk_fma_f32 v[20:21], v[22:23], v[80:81], v[22:23]
    v_pk_mul_f32 v[64:65], v[144:145], v[22:23]
    v_pk_mul_f32 v[72:73], v[146:147], v[20:21]
    v_mfma_f32_32x32x16_bf16 v[144:159], v[120:123], v[32:35], 0
    v_exp_f32 v80, v128
    v_exp_f32 v81, v129
    v_exp_f32_e64 v82, v130
    v_mfma_f32_32x32x16_bf16 v[144:159], v[124:127], v[36:39], v[144:159]
    v_exp_f32 v83, v131
    v_exp_f32 v84, v132
    v_exp_f32_e64 v85, v133
    v_mfma_f32_32x32x16_bf16 v[144:159], v[52:55], v[44:47], v[144:159]
    v_exp_f32 v86, v134
    v_exp_f32 v87, v135
    v_exp_f32_e64 v88, v136
    v_smfmac_f32_16x16x64_bf16 v[200:203], v[212:215], v[64:71], v9
    v_exp_f32 v89, v137
    v_exp_f32 v90, v138
    v_exp_f32_e64 v91, v139
    v_smfmac_f32_16x16x64_bf16 v[204:207], v[212:215], v[72:79], v9
    v_exp_f32 v92, v140
    v_exp_f32 v93, v141
    v_exp_f32 v94, v142
    v_exp_f32 v95, v143
    v_pk_add_f32 v[56:57], v[82:83], 1.0 op_sel_hi:[1,0]
    v_pk_fma_f32 v[58:59], v[56:57], v[80:81], v[56:57]
    v_pk_mul_f32 v[128:129], v[128:129], v[56:57]
    v_pk_fma_f32 v[56:57], v[58:59], v[84:85], v[58:59]
    v_pk_mul_f32 v[132:133], v[132:133], v[58:59]
    v_pk_fma_f32 v[58:59], v[56:57], v[86:87], v[56:57]
    v_pk_mul_f32 v[134:135], v[134:135], v[56:57]
    v_pk_fma_f32 v[56:57], v[58:59], v[88:89], v[58:59]
    v_pk_mul_f32 v[136:137], v[136:137], v[58:59]
    v_pk_fma_f32 v[58:59], v[56:57], v[90:91], v[56:57]
    v_pk_mul_f32 v[138:139], v[138:139], v[56:57]
    v_pk_fma_f32 v[56:57], v[58:59], v[92:93], v[58:59]
    v_pk_mul_f32 v[140:141], v[140:141], v[58:59]
    v_pk_fma_f32 v[2:3], v[56:57], v[94:95], v[56:57]
    v_rcp_f32 v4, v2
    v_rcp_f32 v5, v3
    v_pk_fma_f32 v[186:187], v[0:1], v[2:3], v[186:187]
    v_pk_mul_f32 v[142:143], v[142:143], v[56:57]
    v_pk_fma_f32 v[20:21], v[4:5], v[94:95], v[4:5]
    v_pk_mul_f32 v[78:79], v[142:143], v[4:5]
    v_pk_fma_f32 v[22:23], v[20:21], v[92:93], v[20:21]
    v_pk_mul_f32 v[70:71], v[140:141], v[20:21]
    v_pk_fma_f32 v[20:21], v[22:23], v[90:91], v[22:23]
    v_pk_mul_f32 v[76:77], v[138:139], v[22:23]
    v_pk_fma_f32 v[22:23], v[20:21], v[88:89], v[20:21]
    v_pk_mul_f32 v[68:69], v[136:137], v[20:21]
    v_pk_fma_f32 v[20:21], v[22:23], v[86:87], v[22:23]
    v_pk_mul_f32 v[74:75], v[134:135], v[22:23]
    v_pk_fma_f32 v[22:23], v[20:21], v[84:85], v[20:21]
    v_pk_mul_f32 v[66:67], v[132:133], v[20:21]
    v_pk_fma_f32 v[20:21], v[22:23], v[80:81], v[22:23]
    v_pk_mul_f32 v[64:65], v[128:129], v[22:23]
    v_pk_mul_f32 v[72:73], v[130:131], v[20:21]
    v_add_u32 v15, s64, v15
    s_sub_u32 s40, s40, 1
    s_cbranch_scc1 K2_EVT1
K2_RET1:
    s_waitcnt vmcnt(0) lgkmcnt(0)
    buffer_load_dwordx4 v[112:115], v[210:211], s[16:19], 0 idxen offen offset:0
    buffer_load_dwordx4 v[116:119], v[210:211], s[16:19], 0 idxen offen offset:64
    buffer_load_dwordx4 v[120:123], v[210:211], s[16:19], 0 idxen offen offset:128
    buffer_load_dwordx4 v[124:127], v[210:211], s[16:19], 0 idxen offen offset:192
    ds_read_b128 v[52:55], v216 offset:0
    ds_read_b32 v52, v15 offset:132
    ds_read_u8 v216, v15 offset:258
    ds_read_u16 v210, v14 offset:384
    ds_read_b64_tr_b16 v[212:213], v18 offset:23296
    ds_read_b64_tr_b16 v[214:215], v19 offset:23296
    ds_read_b32 v219, v13 offset:512
    v_mfma_f32_32x32x16_bf16 v[128:143], v[96:99], v[32:35], 0
    v_exp_f32 v80, v144
    v_exp_f32 v81, v145
    v_exp_f32_e64 v82, v146
    v_mfma_f32_32x32x16_bf16 v[128:143], v[100:103], v[36:39], v[128:143]
    v_exp_f32 v83, v147
    v_exp_f32 v84, v148
    v_exp_f32_e64 v85, v149
    v_mfma_f32_32x32x16_bf16 v[128:143], v[48:51], v[40:43], v[128:143]
    v_exp_f32 v86, v150
    v_exp_f32 v87, v151
    v_exp_f32_e64 v88, v152
    v_smfmac_f32_16x16x64_bf16 v[192:195], v[28:31], v[64:71], v9
    v_exp_f32 v89, v153
    v_exp_f32 v90, v154
    v_exp_f32_e64 v91, v155
    v_smfmac_f32_16x16x64_bf16 v[196:199], v[28:31], v[72:79], v9
    v_exp_f32 v92, v156
    v_exp_f32 v93, v157
    v_exp_f32 v94, v158
    v_exp_f32 v95, v159
    v_pk_add_f32 v[56:57], v[82:83], 1.0 op_sel_hi:[1,0]
    v_pk_fma_f32 v[58:59], v[56:57], v[80:81], v[56:57]
    v_pk_mul_f32 v[144:145], v[144:145], v[56:57]
    v_pk_fma_f32 v[56:57], v[58:59], v[84:85], v[58:59]
    v_pk_mul_f32 v[148:149], v[148:149], v[58:59]
    v_pk_fma_f32 v[58:59], v[56:57], v[86:87], v[56:57]
    v_pk_mul_f32 v[150:151], v[150:151], v[56:57]
    v_pk_fma_f32 v[56:57], v[58:59], v[88:89], v[58:59]
    v_pk_mul_f32 v[152:153], v[152:153], v[58:59]
    v_pk_fma_f32 v[58:59], v[56:57], v[90:91], v[56:57]
    v_pk_mul_f32 v[154:155], v[154:155], v[56:57]
    v_pk_fma_f32 v[56:57], v[58:59], v[92:93], v[58:59]
    v_pk_mul_f32 v[156:157], v[156:157], v[58:59]
    v_pk_fma_f32 v[0:1], v[56:57], v[94:95], v[56:57]
    v_rcp_f32 v4, v0
    v_rcp_f32 v5, v1
    v_add_u32_e64 v13, s64, v13
    v_and_or_b32 v18, v218, v12, v13
    v_and_or_b32 v19, v218, v209, v13
    v_pk_mul_f32 v[158:159], v[158:159], v[56:57]
    v_pk_fma_f32 v[20:21], v[4:5], v[94:95], v[4:5]
    v_pk_mul_f32 v[78:79], v[158:159], v[4:5]
    v_pk_fma_f32 v[22:23], v[20:21], v[92:93], v[20:21]
    v_pk_mul_f32 v[70:71], v[156:157], v[20:21]
    v_pk_fma_f32 v[20:21], v[22:23], v[90:91], v[22:23]
    v_pk_mul_f32 v[76:77], v[154:155], v[22:23]
    v_pk_fma_f32 v[22:23], v[20:21], v[88:89], v[20:21]
    v_pk_mul_f32 v[68:69], v[152:153], v[20:21]
    v_pk_fma_f32 v[20:21], v[22:23], v[86:87], v[22:23]
    v_pk_mul_f32 v[74:75], v[150:151], v[22:23]
    v_pk_fma_f32 v[22:23], v[20:21], v[84:85], v[20:21]
    v_pk_mul_f32 v[66:67], v[148:149], v[20:21]
    v_pk_fma_f32 v[20:21], v[22:23], v[80:81], v[22:23]
    v_pk_mul_f32 v[64:65], v[144:145], v[22:23]
    v_pk_mul_f32 v[72:73], v[146:147], v[20:21]
    s_branch K2_LOOP
.p2align 3
K2_LAST0:
    s_waitcnt lgkmcnt(0)
    v_mov_b64 v[28:29], v[212:213]
    v_mov_b64 v[30:31], v[214:215]
K2_LAST1:
    s_add_u32 s48, s46, 1
    s_waitcnt lgkmcnt(0)
    v_lshlrev_b32_e64 v16, 2, v10
    s_cmp_lt_u32 s3, 4
    s_cbranch_scc1 K2_LAST2
    s_setprio 0
    buffer_load_dwordx4 v[96:99], v16, s[12:15], s92 offen offset:0
    buffer_load_dwordx4 v[100:103], v16, s[12:15], s92 offen offset:1024
    buffer_load_dwordx4 v[104:107], v16, s[12:15], s92 offen offset:2048
    buffer_load_dwordx4 v[108:111], v16, s[12:15], s92 offen offset:3072
    buffer_load_dwordx4 v[112:115], v16, s[12:15], s93 offen offset:0
    buffer_load_dwordx4 v[116:119], v16, s[12:15], s93 offen offset:1024
    buffer_load_dwordx4 v[120:123], v16, s[12:15], s93 offen offset:2048
    buffer_load_dwordx4 v[124:127], v16, s[12:15], s93 offen offset:3072
K2_LAST2:
    v_exp_f32 v80, v144
    v_exp_f32 v81, v145
    v_exp_f32 v82, v146
    v_exp_f32 v83, v147
    v_exp_f32 v84, v148
    v_exp_f32 v85, v149
    v_exp_f32 v86, v150
    v_exp_f32 v87, v151
    v_exp_f32_e64 v88, v152
    v_smfmac_f32_16x16x64_bf16 v[192:195], v[28:31], v[64:71], v9
    v_exp_f32 v89, v153
    v_exp_f32 v90, v154
    v_exp_f32_e64 v91, v155
    v_smfmac_f32_16x16x64_bf16 v[196:199], v[28:31], v[72:79], v9
    v_exp_f32 v92, v156
    v_exp_f32 v93, v157
    v_exp_f32 v94, v158
    v_exp_f32 v95, v159
    v_pk_add_f32 v[56:57], v[82:83], 1.0 op_sel_hi:[1,0]
    v_pk_fma_f32 v[58:59], v[56:57], v[80:81], v[56:57]
    v_pk_mul_f32 v[144:145], v[144:145], v[56:57]
    v_pk_fma_f32 v[56:57], v[58:59], v[84:85], v[58:59]
    v_pk_mul_f32 v[148:149], v[148:149], v[58:59]
    v_pk_fma_f32 v[58:59], v[56:57], v[86:87], v[56:57]
    v_pk_mul_f32 v[150:151], v[150:151], v[56:57]
    v_pk_fma_f32 v[56:57], v[58:59], v[88:89], v[58:59]
    v_pk_mul_f32 v[152:153], v[152:153], v[58:59]
    v_pk_fma_f32 v[58:59], v[56:57], v[90:91], v[56:57]
    v_pk_mul_f32 v[154:155], v[154:155], v[56:57]
    v_pk_fma_f32 v[56:57], v[58:59], v[92:93], v[58:59]
    v_pk_mul_f32 v[156:157], v[156:157], v[58:59]
    v_pk_fma_f32 v[0:1], v[56:57], v[94:95], v[56:57]
    v_rcp_f32 v4, v0
    v_rcp_f32 v5, v1
    v_pk_mul_f32 v[158:159], v[158:159], v[56:57]
    v_pk_fma_f32 v[20:21], v[4:5], v[94:95], v[4:5]
    v_pk_mul_f32 v[78:79], v[158:159], v[4:5]
    v_pk_fma_f32 v[22:23], v[20:21], v[92:93], v[20:21]
    v_pk_mul_f32 v[70:71], v[156:157], v[20:21]
    v_pk_fma_f32 v[20:21], v[22:23], v[90:91], v[22:23]
    v_pk_mul_f32 v[76:77], v[154:155], v[22:23]
    v_pk_fma_f32 v[22:23], v[20:21], v[88:89], v[20:21]
    v_pk_mul_f32 v[68:69], v[152:153], v[20:21]
    v_pk_fma_f32 v[20:21], v[22:23], v[86:87], v[22:23]
    v_pk_mul_f32 v[74:75], v[150:151], v[22:23]
    v_pk_fma_f32 v[22:23], v[20:21], v[84:85], v[20:21]
    v_pk_mul_f32 v[66:67], v[148:149], v[20:21]
    v_pk_fma_f32 v[20:21], v[22:23], v[80:81], v[22:23]
    v_pk_mul_f32 v[64:65], v[144:145], v[22:23]
    v_pk_mul_f32 v[72:73], v[146:147], v[20:21]
K2_DONE:
    v_pk_add_f32 v[186:187], v[186:187], v[0:1]
K2S_DONE:
    v_smfmac_f32_16x16x64_bf16 v[200:203], v[28:31], v[64:71], v9
    v_smfmac_f32_16x16x64_bf16 v[204:207], v[28:31], v[72:79], v9
    v_add_f32 v186, v186, v187
    v_lshrrev_b32 v22, 2, v10
    v_mad_u32_u24 v0, s48, v217, v8
    s_not_b64 s[58:59], s[96:97]
    v_cndmask_b32 v7, v7, v0, s[96:97]
    v_cmp_ngt_f32 vcc, 1602224128, v186
    s_mov_b32 s35, 2
    s_cbranch_vccnz K2_OVER
K2_OVERRET:
    s_cmp_lt_u32 s3, 4
    s_cbranch_scc1 K2_FLUSH
K2_PAD6:
    s_cbranch_execz K1_PADLINK7
    s_setprio 3
    v_lshrrev_b32 v57, 5, v22
    v_bfe_u32 v58, v22, 4, 1
    s_lshl_b32 s50, s69, 6
    v_lshl_or_b32 v58, v57, 2, v58
    v_and_or_b32 v14, v10, 60, s50
    v_mul_u32_u24 v59, 272, v58
    v_and_b32 v56, 31, v22
    v_xor_b32 v15, v14, v59
    v_lshlrev_b32 v59, 4, v56
    v_xor_b32 v13, 32, v15
    v_xor_b32 v12, 128, v15
    v_xor_b32 v11, 160, v15
    v_lshl_or_b32 v59, v57, 3, v59
    ds_read2st64_b32 v[64:65], v15 offset0:76 offset1:92
    ds_read2st64_b32 v[66:67], v15 offset0:108 offset1:124
    ds_read2st64_b32 v[68:69], v13 offset0:78 offset1:94
    ds_read2st64_b32 v[70:71], v12 offset0:84 offset1:100
    ds_read2st64_b32 v[72:73], v11 offset0:86 offset1:102
    ds_read_b32 v74, v13 offset:28160
    ds_read_b32 v75, v12 offset:29696
    ds_read_b32 v76, v11 offset:30208
    v_mul_u32_u24 v56, 784, v56
    v_lshl_add_u32 v56, v57, 4, v56
    v_add_u32 v56, 113536, v56
K2_FLUSH:
    s_cmp_lg_u32 s33, -1
    s_cbranch_scc1 K2_SYNC
K2_SYNCED:
    s_cmp_eq_u32 s46, s65
    s_cselect_b64 exec, s[58:59], -1
    v_pk_mul_f32 v[2:3], v[192:193], v[24:25] op_sel:[0,0] op_sel_hi:[1,0]
    v_pk_mul_f32 v[4:5], v[194:195], v[24:25] op_sel:[0,0] op_sel_hi:[1,0]
    v_cvt_pk_bf16_f32 v0, v192, v196
    v_pk_fma_f32 v[2:3], v[196:197], v[24:25], v[2:3] op_sel:[0,1,0] op_sel_hi:[1,1,1]
    v_pk_fma_f32 v[4:5], v[198:199], v[24:25], v[4:5] op_sel:[0,1,0] op_sel_hi:[1,1,1]
    v_cvt_pk_bf16_f32 v1, v200, v204
    v_pk_fma_f32 v[2:3], v[200:201], v[26:27], v[2:3] op_sel:[0,0,0] op_sel_hi:[1,0,1]
    v_pk_fma_f32 v[4:5], v[202:203], v[26:27], v[4:5] op_sel:[0,0,0] op_sel_hi:[1,0,1]
    v_pk_fma_f32 v[2:3], v[204:205], v[26:27], v[2:3] op_sel:[0,1,0] op_sel_hi:[1,1,1]
    v_pk_fma_f32 v[4:5], v[206:207], v[26:27], v[4:5] op_sel:[0,1,0] op_sel_hi:[1,1,1]
    ds_write_b64 v7, v[0:1]
    ds_write2_b64 v7, v[2:3], v[4:5] offset0:32 offset1:64
    s_mov_b64 exec, -1
    s_cmp_lt_u32 s3, 4
    s_cbranch_scc1 K2_POS
    ds_read_b64 v[80:81], v59 offset:2048
    ds_read_b64 v[84:85], v59 offset:2560
    s_waitcnt lgkmcnt(2)
    s_barrier
    ds_read_b32 v0, v10 offset:640
    ds_read_b128 v[192:195], v56 offset:25088
    ds_read_b128 v[196:199], v56 offset:25120
    ds_read_b128 v[200:203], v56 offset:25152
    ds_read_b128 v[204:207], v56 offset:25184
    ds_read_b128 v[208:211], v56 offset:25216
    ds_read_b128 v[212:215], v56 offset:25248
    ds_read_b128 v[216:219], v56 offset:25280
    ds_read_b128 v[220:223], v56 offset:25312
    ds_read_b128 v[224:227], v56 offset:0
    ds_read_b128 v[228:231], v56 offset:32
    ds_read_b128 v[232:235], v56 offset:64
    ds_read_b128 v[236:239], v56 offset:96
    ds_read_b128 v[240:243], v56 offset:128
    ds_read_b128 v[244:247], v56 offset:160
    s_mul_i32 s48, s2, 12544
    s_add_u32 s56, s20, s48
    s_addc_u32 s57, s21, 0
    s_mov_b64 s[58:59], s[6:7]
    s_mov_b32 s50, 0xffff0000
    s_mov_b32 s60, 1065376154
    s_mov_b32 s61, s60
    s_waitcnt vmcnt(0)
    s_waitcnt lgkmcnt(13)
    ds_read_b128 v[248:251], v56 offset:192
    ds_read_b128 v[252:255], v56 offset:224
    v_mfma_f32_32x32x16_bf16 v[176:191], v[192:195], v[96:99], v[176:191]
    v_cmp_lt_u32 vcc, 1, v0
    v_lshl_or_b32 v14, v58, 8, v14
    v_mov_b64 v[82:83], 0
    s_waitcnt lgkmcnt(14)
    v_mfma_f32_32x32x16_bf16 v[176:191], v[196:199], v[100:103], v[176:191]
    v_mov_b64 v[86:87], 0
    v_mov_b64 v[90:91], 0
    s_mov_b32 s48, 3207720526
    s_waitcnt lgkmcnt(13)
    v_mfma_f32_32x32x16_bf16 v[176:191], v[200:203], v[104:107], v[176:191]
    s_mov_b32 s49, s48
    s_movk_i32 s53, 4096
    s_waitcnt lgkmcnt(12)
    v_mfma_f32_32x32x16_bf16 v[176:191], v[204:207], v[108:111], v[176:191]
    s_movk_i32 s54, 8192
    s_movk_i32 s55, 12288
    s_waitcnt lgkmcnt(11)
    v_mfma_f32_32x32x16_bf16 v[176:191], v[208:211], v[112:115], v[176:191]
    v_lshlrev_b32 v24, 16, v64
    v_and_b32 v25, s50, v64
    s_waitcnt lgkmcnt(10)
    v_mfma_f32_32x32x16_bf16 v[176:191], v[212:215], v[116:119], v[176:191]
    v_lshlrev_b32 v26, 16, v68
    v_and_b32 v27, s50, v68
    s_waitcnt lgkmcnt(9)
    v_mfma_f32_32x32x16_bf16 v[176:191], v[216:219], v[120:123], v[176:191]
    v_lshlrev_b32 v28, 16, v70
    v_and_b32 v29, s50, v70
    s_waitcnt lgkmcnt(8)
    v_mfma_f32_32x32x16_bf16 v[176:191], v[220:223], v[124:127], v[176:191]
    v_lshlrev_b32 v30, 16, v72
    v_and_b32 v31, s50, v72
    v_lshlrev_b32 v32, 16, v65
    v_and_b32 v33, s50, v65
    v_lshlrev_b32 v34, 16, v69
    s_waitcnt lgkmcnt(7)
    v_mfma_f32_32x32x16_bf16 v[160:175], v[224:227], v[96:99], v[160:175]
    v_and_b32 v35, s50, v69
    v_lshlrev_b32 v36, 16, v71
    v_and_b32 v37, s50, v71
    v_lshlrev_b32 v38, 16, v73
    v_and_b32 v39, s50, v73
    v_cvt_pk_bf16_f32 v88, v188, v189
    v_cvt_pk_bf16_f32 v89, v190, v191
    s_waitcnt lgkmcnt(6)
    v_mfma_f32_32x32x16_bf16 v[160:175], v[228:231], v[100:103], v[160:175]
    v_mfma_f32_32x32x16_bf16 v[176:191], v[84:87], v[88:91], v[176:191]
    v_lshlrev_b32 v40, 16, v66
    v_and_b32 v41, s50, v66
    v_lshlrev_b32 v42, 16, v74
    v_and_b32 v43, s50, v74
    v_lshlrev_b32 v44, 16, v75
    s_waitcnt lgkmcnt(5)
    v_mfma_f32_32x32x16_bf16 v[160:175], v[232:235], v[104:107], v[160:175]
    v_and_b32 v45, s50, v75
    v_lshlrev_b32 v46, 16, v76
    v_and_b32 v47, s50, v76
    v_lshlrev_b32 v48, 16, v67
    v_and_b32 v49, s50, v67
    s_waitcnt lgkmcnt(4)
    v_mfma_f32_32x32x16_bf16 v[160:175], v[236:239], v[108:111], v[160:175]
    v_mul_f32 v144, s60, v176
    v_mul_f32 v145, s60, v177
    v_mul_f32 v146, s60, v178
    v_mul_f32 v147, s60, v179
    v_mul_f32 v148, s60, v180
    v_mul_f32 v149, s60, v181
    s_waitcnt lgkmcnt(3)
    v_mfma_f32_32x32x16_bf16 v[160:175], v[240:243], v[112:115], v[160:175]
    v_mul_f32 v150, s60, v182
    v_mul_f32 v151, s60, v183
    v_mul_f32 v152, s60, v184
    v_exp_f32 v144, v144
    v_exp_f32 v145, v145
    v_exp_f32 v146, v146
    s_waitcnt lgkmcnt(2)
    v_mfma_f32_32x32x16_bf16 v[160:175], v[244:247], v[116:119], v[160:175]
    v_exp_f32 v147, v147
    v_exp_f32 v148, v148
    v_exp_f32 v149, v149
    v_exp_f32 v150, v150
    s_waitcnt lgkmcnt(1)
    v_mfma_f32_32x32x16_bf16 v[160:175], v[248:251], v[120:123], v[160:175]
    v_exp_f32 v151, v151
    v_exp_f32 v152, v152
    v_add_f32 v144, 1.0, v144
    v_add_f32 v145, 1.0, v145
    v_add_f32 v146, 1.0, v146
    v_add_f32 v147, 1.0, v147
    s_waitcnt lgkmcnt(0)
    v_mfma_f32_32x32x16_bf16 v[160:175], v[252:255], v[124:127], v[160:175]
    v_add_f32 v148, 1.0, v148
    v_add_f32 v149, 1.0, v149
    v_add_f32 v150, 1.0, v150
    v_add_f32 v151, 1.0, v151
    v_add_f32 v152, 1.0, v152
    v_rcp_f32 v144, v144
    v_mfma_f32_32x32x16_bf16 v[160:175], v[80:83], v[88:91], v[160:175]
    v_rcp_f32 v145, v145
    v_rcp_f32 v146, v146
    v_rcp_f32 v147, v147
    v_rcp_f32 v148, v148
    v_rcp_f32 v149, v149
    v_rcp_f32 v150, v150
    v_rcp_f32 v151, v151
    v_rcp_f32 v152, v152
    s_or_b32 s52, s34, vcc_lo
    s_cbranch_scc1 K2_MORE
K2_PAD7:
    s_cbranch_execz K1_PADEND
    v_pk_mul_f32 v[144:145], v[144:145], v[176:177]
    v_pk_mul_f32 v[146:147], v[146:147], v[178:179]
    v_pk_mul_f32 v[148:149], v[148:149], v[180:181]
    v_pk_mul_f32 v[150:151], v[150:151], v[182:183]
    v_pk_mul_f32 v[152:153], v[152:153], v[184:185]
    v_permlane16_swap_b32 v144, v145
    v_permlane16_swap_b32 v146, v147
    v_permlane16_swap_b32 v148, v149
    v_permlane16_swap_b32 v150, v151
    v_permlane16_swap_b32 v152, v153
    v_pk_fma_f32 v[144:145], v[144:145], s[48:49], v[40:41]
    v_pk_fma_f32 v[146:147], v[146:147], s[48:49], v[42:43]
    v_pk_fma_f32 v[148:149], v[148:149], s[48:49], v[44:45]
    v_pk_fma_f32 v[150:151], v[150:151], s[48:49], v[46:47]
    v_pk_fma_f32 v[152:153], v[152:153], s[48:49], v[48:49]
    v_cvt_pk_bf16_f32 v72, v144, v145
    v_cvt_pk_bf16_f32 v73, v146, v147
    v_cvt_pk_bf16_f32 v74, v148, v149
    v_cvt_pk_bf16_f32 v75, v150, v151
    v_cvt_pk_bf16_f32 v76, v152, v153
    buffer_store_dword v72, v14, s[56:59], s54 offen offset:0 sc0 sc1
    buffer_store_dword v73, v14, s[56:59], s54 offen offset:512 sc0 sc1
    buffer_store_dword v74, v14, s[56:59], s54 offen offset:2048 sc0 sc1
    buffer_store_dword v75, v14, s[56:59], s54 offen offset:2560 sc0 sc1
    buffer_store_dword v76, v14, s[56:59], s55 offen offset:0 sc0 sc1
    v_pk_mul_f32 v[128:129], v[160:161], s[60:61]
    v_pk_mul_f32 v[130:131], v[162:163], s[60:61]
    v_pk_mul_f32 v[132:133], v[164:165], s[60:61]
    v_exp_f32 v128, v128
    v_exp_f32 v129, v129
    v_exp_f32 v130, v130
    v_exp_f32 v131, v131
    v_exp_f32 v132, v132
    v_exp_f32 v133, v133
    v_pk_add_f32 v[128:129], v[128:129], 1.0 op_sel_hi:[1,0]
    v_pk_add_f32 v[130:131], v[130:131], 1.0 op_sel_hi:[1,0]
    v_pk_add_f32 v[132:133], v[132:133], 1.0 op_sel_hi:[1,0]
    v_rcp_f32 v128, v128
    v_rcp_f32 v129, v129
    v_rcp_f32 v130, v130
    v_rcp_f32 v131, v131
    v_rcp_f32 v132, v132
    v_rcp_f32 v133, v133
    v_pk_mul_f32 v[128:129], v[128:129], v[160:161]
    v_pk_mul_f32 v[130:131], v[130:131], v[162:163]
    v_pk_mul_f32 v[132:133], v[132:133], v[164:165]
    v_permlane16_swap_b32 v128, v129
    v_permlane16_swap_b32 v130, v131
    v_permlane16_swap_b32 v132, v133
    v_pk_fma_f32 v[128:129], v[128:129], s[48:49], v[24:25]
    v_pk_fma_f32 v[130:131], v[130:131], s[48:49], v[26:27]
    v_pk_fma_f32 v[132:133], v[132:133], s[48:49], v[28:29]
    v_cvt_pk_bf16_f32 v64, v128, v129
    v_cvt_pk_bf16_f32 v65, v130, v131
    v_cvt_pk_bf16_f32 v66, v132, v133
    buffer_store_dword v64, v14, s[56:59], 0 offen offset:0 sc0 sc1
    buffer_store_dword v65, v14, s[56:59], 0 offen offset:512 sc0 sc1
    buffer_store_dword v66, v14, s[56:59], 0 offen offset:2048 sc0 sc1
    v_pk_mul_f32 v[134:135], v[166:167], s[60:61]
    v_pk_mul_f32 v[136:137], v[168:169], s[60:61]
    v_pk_mul_f32 v[138:139], v[170:171], s[60:61]
    v_exp_f32 v134, v134
    v_exp_f32 v135, v135
    v_exp_f32 v136, v136
    v_exp_f32 v137, v137
    v_exp_f32 v138, v138
    v_exp_f32 v139, v139
    v_pk_add_f32 v[134:135], v[134:135], 1.0 op_sel_hi:[1,0]
    v_pk_add_f32 v[136:137], v[136:137], 1.0 op_sel_hi:[1,0]
    v_pk_add_f32 v[138:139], v[138:139], 1.0 op_sel_hi:[1,0]
    v_rcp_f32 v134, v134
    v_rcp_f32 v135, v135
    v_rcp_f32 v136, v136
    v_rcp_f32 v137, v137
    v_rcp_f32 v138, v138
    v_rcp_f32 v139, v139
    v_pk_mul_f32 v[134:135], v[134:135], v[166:167]
    v_pk_mul_f32 v[136:137], v[136:137], v[168:169]
    v_pk_mul_f32 v[138:139], v[138:139], v[170:171]
    v_permlane16_swap_b32 v134, v135
    v_permlane16_swap_b32 v136, v137
    v_permlane16_swap_b32 v138, v139
    v_pk_fma_f32 v[134:135], v[134:135], s[48:49], v[30:31]
    v_pk_fma_f32 v[136:137], v[136:137], s[48:49], v[32:33]
    v_pk_fma_f32 v[138:139], v[138:139], s[48:49], v[34:35]
    v_cvt_pk_bf16_f32 v67, v134, v135
    v_cvt_pk_bf16_f32 v68, v136, v137
    v_cvt_pk_bf16_f32 v69, v138, v139
    buffer_store_dword v67, v14, s[56:59], 0 offen offset:2560 sc0 sc1
    buffer_store_dword v68, v14, s[56:59], s53 offen offset:0 sc0 sc1
    buffer_store_dword v69, v14, s[56:59], s53 offen offset:512 sc0 sc1
    v_pk_mul_f32 v[140:141], v[172:173], s[60:61]
    v_pk_mul_f32 v[142:143], v[174:175], s[60:61]
    v_exp_f32 v140, v140
    v_exp_f32 v141, v141
    v_exp_f32 v142, v142
    v_exp_f32 v143, v143
    v_pk_add_f32 v[140:141], v[140:141], 1.0 op_sel_hi:[1,0]
    v_pk_add_f32 v[142:143], v[142:143], 1.0 op_sel_hi:[1,0]
    v_rcp_f32 v140, v140
    v_rcp_f32 v141, v141
    v_rcp_f32 v142, v142
    v_rcp_f32 v143, v143
    v_pk_mul_f32 v[140:141], v[140:141], v[172:173]
    v_pk_mul_f32 v[142:143], v[142:143], v[174:175]
    s_nop 0
    v_permlane16_swap_b32 v140, v141
    v_permlane16_swap_b32 v142, v143
    v_pk_fma_f32 v[140:141], v[140:141], s[48:49], v[36:37]
    v_pk_fma_f32 v[142:143], v[142:143], s[48:49], v[38:39]
    v_cvt_pk_bf16_f32 v70, v140, v141
    v_cvt_pk_bf16_f32 v71, v142, v143
    buffer_store_dword v70, v14, s[56:59], s53 offen offset:2048 sc0 sc1
    buffer_store_dword v71, v14, s[56:59], s53 offen offset:2560 sc0 sc1
K2_EXIT:
    s_endpgm
.p2align 12
K2_PAD8:
    s_branch K1_PADLINK9
K2_POS:
    s_waitcnt lgkmcnt(0)
    s_barrier
    s_lshr_b32 s48, s3, 1
    s_mul_i32 s48, s48, 25
    s_and_b32 s50, s3, 1
    s_lshl_b32 s49, s50, 8
    s_add_u32 s49, s49, 113792
    v_and_b32 v1, 31, v22
    v_lshrrev_b32 v2, 5, v22
    v_cmp_gt_u32 vcc, 25, v1
    v_add_u32 v3, 32, v1
    v_add_u32 v4, s48, v1
    v_lshlrev_b32 v1, 2, v1
    v_cndmask_b32 v4, v3, v4, vcc
    ds_read_b32 v3, v1 offset:416
    v_lshl_add_u32 v1, v2, 7, s49
    s_mov_b32 s48, 784
    v_mad_u32_u24 v56, v4, s48, v1
    ds_read_b32 v0, v10 offset:640
    s_waitcnt lgkmcnt(0)
    v_lshl_add_u32 v5, s50, 1, v2
    v_lshl_add_u32 v1, v4, 2, v5
    v_lshlrev_b32 v1, 2, v1
    ds_read_b32 v1, v1 offset:1020
    s_lshl_b32 s49, s3, 9
    v_lshl_add_u32 v2, v2, 2, s49
    v_add_u32 v3, v3, v2
    v_lshl_add_u32 v2, v4, 3, v2
    v_mul_u32_u24 v4, 6, v4
    v_add_u32 v5, -1, v5
    s_mul_i32 s48, s2, 294
    s_sub_u32 s58, 75000, s48
    s_min_u32 s58, s58, 294
    s_add_u32 s48, s48, 3200000
    s_add_u32 s56, s20, s48
    s_addc_u32 s57, s21, 0
    s_mov_b32 s59, 131072
    v_cmp_gt_u32 s[52:53], s58, v4
    v_lshl_add_u32 v5, v5, 1, v4
    s_add_u32 s58, s58, 2
    s_mul_i32 s52, s52, s50
    ds_read_b128 v[192:195], v56 offset:0
    ds_read_b128 v[196:199], v56 offset:16
    ds_read_b128 v[200:203], v56 offset:32
    s_waitcnt lgkmcnt(1)
    v_cmp_lt_u32 vcc, 1, v0
    v_add_f32 v192, v192, v196
    v_add_f32 v193, v193, v197
    v_add_f32 v194, v194, v198
    v_add_f32 v195, v195, v199
    ds_read_b128 v[204:207], v56 offset:48
    s_waitcnt lgkmcnt(1)
    v_add_f32 v192, v192, v200
    v_add_f32 v193, v193, v201
    v_add_f32 v194, v194, v202
    v_add_f32 v195, v195, v203
    ds_read_b128 v[208:211], v56 offset:64
    s_waitcnt lgkmcnt(1)
    v_add_f32 v192, v192, v204
    v_add_f32 v193, v193, v205
    v_add_f32 v194, v194, v206
    v_add_f32 v195, v195, v207
    ds_read_b128 v[212:215], v56 offset:80
    s_waitcnt lgkmcnt(1)
    v_add_f32 v192, v192, v208
    v_add_f32 v193, v193, v209
    v_add_f32 v194, v194, v210
    v_add_f32 v195, v195, v211
    ds_read_b128 v[216:219], v56 offset:96
    s_waitcnt lgkmcnt(1)
    v_add_f32 v192, v192, v212
    v_add_f32 v193, v193, v213
    v_add_f32 v194, v194, v214
    v_add_f32 v195, v195, v215
    ds_read_b128 v[220:223], v56 offset:112
    s_waitcnt lgkmcnt(1)
    v_add_f32 v192, v192, v216
    v_add_f32 v193, v193, v217
    v_add_f32 v194, v194, v218
    v_add_f32 v195, v195, v219
    s_waitcnt lgkmcnt(0)
    v_add_f32 v192, v192, v220
    v_add_f32 v193, v193, v221
    v_add_f32 v194, v194, v222
    v_add_f32 v195, v195, v223
    v_add_f32 v192, v192, v194
    v_add_f32 v193, v193, v195
    s_nop 1
    v_permlane32_swap_b32 v192, v193
    v_add_f32 v192, v192, v193
    v_add_f32 v188, v188, v192
    ds_write_b32 v2, v188 offset:33792
    s_mov_b32 exec_lo, 0xfe000000
    s_mov_b32 exec_hi, 0xfe000000
    ds_add_f32 v3, v192 offset:33784
    s_mov_b64 exec, -1
    ds_read_b32 v188, v2 offset:33792
    s_or_b32 s48, s34, vcc_lo
    s_cbranch_scc1 K2_MORE
    s_mov_b64 exec, s[52:53]
    s_waitcnt lgkmcnt(0)
    v_add_f32 v1, v1, v188
    v_cvt_pk_bf16_f32 v1, v1, v1
    buffer_store_short v1, v5, s[56:59], 0 offen
    s_endpgm
K2_PAD9:
    s_branch K1_PADLINK10
K2_BULK:
    s_cmp_lg_u32 s37, 0
    s_cbranch_scc1 K2_CONST
    s_mul_i32 s50, s2, 12544
    v_lshrrev_b32 v3, 4, v22
    v_and_b32 v4, 15, v22
    s_lshl_b32 s51, s69, 2
    v_or_b32 v2, s51, v3
    v_xor_b32 v2, v2, v4
    v_lshlrev_b32 v2, 4, v2
    v_lshl_or_b32 v2, v3, 8, v2
    s_lshl_b32 s52, s69, 10
    s_lshl_b32 s54, s69, 13
    s_add_u32 s54, s54, 3211264
    s_add_u32 s94, s54, 4096
    s_add_u32 m0, s52, 19456
    s_mul_i32 s60, s69, 19456
    s_add_u32 s56, s54, 32768
    s_add_u32 s57, s54, 36864
    s_add_u32 s92, s54, 65536
    s_add_u32 s93, s54, 69632
    s_waitcnt lgkmcnt(0)
    s_add_u32 s4, s4, s50
    s_addc_u32 s5, s5, 0
    s_barrier
    buffer_load_dwordx4 v2, s[4:7], s52 offen lds
    s_add_u32 m0, m0, 4096
    s_add_u32 s52, s52, 4096
    buffer_load_dwordx4 v2, s[4:7], s52 offen lds
    s_add_u32 m0, m0, 4096
    s_add_u32 s52, s52, 4096
    buffer_load_dwordx4 v2, s[4:7], s52 offen lds
    s_cmp_ge_u32 s3, 6
    s_cbranch_scc1 K2_JOB67
    s_add_u32 m0, m0, 4096
    s_add_u32 s52, s52, 4096
    buffer_load_dwordx4 v2, s[4:7], s52 offen lds
K2_JOBRET:
    buffer_load_dwordx4 v[96:99], v5, s[12:15], s54 offen offset:0
    buffer_load_dwordx4 v[100:103], v5, s[12:15], s54 offen offset:1024
    buffer_load_dwordx4 v[104:107], v5, s[12:15], s54 offen offset:2048
    buffer_load_dwordx4 v[108:111], v5, s[12:15], s54 offen offset:3072
    buffer_load_dwordx4 v[112:115], v5, s[12:15], s94 offen offset:0
    s_branch K2_CONST
K2_BULK2:
    s_cmp_lg_u32 s37, 0
    s_cbranch_scc1 K2_BSKIP
    buffer_load_dwordx4 v[116:119], v5, s[12:15], s94 offen offset:1024
    buffer_load_dwordx4 v[120:123], v5, s[12:15], s94 offen offset:2048
    buffer_load_dwordx4 v[124:127], v5, s[12:15], s94 offen offset:3072
    s_add_u32 s16, s12, 4194304
    s_addc_u32 s17, s13, 0
    s_or_b32 s17, s17, 16777216
    s_mov_b32 s18, 12500
    s_mov_b32 s19, 131072
    v_and_b32 v4, 15, v22
    v_lshrrev_b32 v1, 5, v22
    v_and_b32 v3, 31, v22
    v_xor_b32 v2, v1, v4
    v_lshlrev_b32 v2, 4, v2
    v_lshl_or_b32 v56, v3, 8, v2
    v_xor_b32 v57, 32, v56
    v_xor_b32 v58, 64, v56
    v_xor_b32 v59, 96, v56
    v_xor_b32 v60, 128, v56
    v_xor_b32 v61, 160, v56
    v_xor_b32 v62, 192, v56
    v_xor_b32 v63, 224, v56
    v_and_b32 v2, 124, v10
    v_lshl_or_b32 v2, v1, 10, v2
    s_lshl_b32 s50, s69, 7
    s_add_u32 s50, s50, 5120
    v_add_u32 v0, s50, v2
    s_mov_b32 s48, 3216550459
    s_mov_b32 s49, 3216550459
    v_lshlrev_b32 v48, 1, v10
    v_and_b32 v49, 496, v5
    s_waitcnt vmcnt(8)
    ds_write_b32 v91, v92 offset:560
    s_cmp_eq_u32 s3, 7
    s_cbranch_scc0 K2_HWAIT
    v_lshlrev_b32 v2, 16, v20
    v_and_b32 v3, 0xffff0000, v20
    v_lshlrev_b32 v4, 16, v21
    ds_write_b96 v5, v[2:4] offset:1024
K2_HWAIT:
    ds_read_b32 v1, v10 offset:560
    s_waitcnt lgkmcnt(0)
    v_cmp_eq_u32 vcc, 1, v1
    s_cmp_eq_u32 vcc_lo, 0xf0
    s_cbranch_scc0 K2_HWAIT
K2_PAD10:
    s_cbranch_execz K1_PADEND
    ds_read_b32 v40, v48 offset:4096
    ds_read_b32 v44, v48 offset:4100
    ds_read_b128 v[24:27], v49 offset:4608
    ds_read_b128 v[128:131], v56 offset:19456
    ds_read_b128 v[132:135], v56 offset:27648
    ds_read_b128 v[136:139], v57 offset:19456
    ds_read_b128 v[140:143], v57 offset:27648
    ds_read_b128 v[144:147], v58 offset:19456
    ds_read_b128 v[148:151], v58 offset:27648
    ds_read_b128 v[152:155], v59 offset:19456
    ds_read_b128 v[156:159], v59 offset:27648
    s_waitcnt vmcnt(7) lgkmcnt(7)
    v_mfma_f32_32x32x16_bf16 v[224:239], v[128:131], v[96:99], 0
    ds_read_b128 v[128:131], v60 offset:19456
    s_waitcnt lgkmcnt(7)
    v_mfma_f32_32x32x16_bf16 v[240:255], v[132:135], v[96:99], 0
    ds_read_b128 v[132:135], v60 offset:27648
    s_waitcnt vmcnt(6) lgkmcnt(7)
    v_mfma_f32_32x32x16_bf16 v[224:239], v[136:139], v[100:103], v[224:239]
    ds_read_b128 v[136:139], v61 offset:19456
    s_waitcnt lgkmcnt(7)
    v_mfma_f32_32x32x16_bf16 v[240:255], v[140:143], v[100:103], v[240:255]
    ds_read_b128 v[140:143], v61 offset:27648
    s_waitcnt vmcnt(5) lgkmcnt(7)
    v_mfma_f32_32x32x16_bf16 v[224:239], v[144:147], v[104:107], v[224:239]
    ds_read_b128 v[144:147], v62 offset:19456
    s_waitcnt lgkmcnt(7)
    v_mfma_f32_32x32x16_bf16 v[240:255], v[148:151], v[104:107], v[240:255]
    ds_read_b128 v[148:151], v62 offset:27648
    s_waitcnt vmcnt(4) lgkmcnt(7)
    v_mfma_f32_32x32x16_bf16 v[224:239], v[152:155], v[108:111], v[224:239]
    ds_read_b128 v[152:155], v63 offset:19456
    s_waitcnt lgkmcnt(7)
    v_mfma_f32_32x32x16_bf16 v[240:255], v[156:159], v[108:111], v[240:255]
    ds_read_b128 v[156:159], v63 offset:27648
    s_waitcnt vmcnt(3) lgkmcnt(7)
    v_mfma_f32_32x32x16_bf16 v[224:239], v[128:131], v[112:115], v[224:239]
    s_waitcnt lgkmcnt(6)
    v_mfma_f32_32x32x16_bf16 v[240:255], v[132:135], v[112:115], v[240:255]
    s_add_u32 s61, s60, 0
    buffer_load_dwordx4 v[160:163], v5, s[8:11], s61 offen offset:0
    s_waitcnt vmcnt(3) lgkmcnt(5)
    v_mfma_f32_32x32x16_bf16 v[224:239], v[136:139], v[116:119], v[224:239]
    buffer_load_dwordx4 v[164:167], v5, s[8:11], s61 offen offset:1024
    s_waitcnt lgkmcnt(4)
    v_mfma_f32_32x32x16_bf16 v[240:255], v[140:143], v[116:119], v[240:255]
    buffer_load_dwordx4 v[168:171], v5, s[8:11], s61 offen offset:2048
    s_waitcnt vmcnt(4) lgkmcnt(3)
    v_mfma_f32_32x32x16_bf16 v[224:239], v[144:147], v[120:123], v[224:239]
    buffer_load_dwordx4 v[172:175], v5, s[8:11], s61 offen offset:3072
    s_waitcnt lgkmcnt(2)
    v_mfma_f32_32x32x16_bf16 v[240:255], v[148:151], v[120:123], v[240:255]
    s_add_u32 s61, s60, 4096
    buffer_load_dwordx4 v[176:179], v5, s[8:11], s61 offen offset:0
    s_waitcnt vmcnt(5) lgkmcnt(1)
    v_mfma_f32_32x32x16_bf16 v[224:239], v[152:155], v[124:127], v[224:239]
    buffer_load_dwordx4 v[180:183], v5, s[8:11], s61 offen offset:1024
    s_waitcnt lgkmcnt(0)
    v_mfma_f32_32x32x16_bf16 v[240:255], v[156:159], v[124:127], v[240:255]
    buffer_load_dwordx4 v[184:187], v5, s[8:11], s61 offen offset:2048
    s_nop 7
    v_pk_mul_f32 v[224:225], v[224:225], s[48:49]
    v_pk_mul_f32 v[226:227], v[226:227], s[48:49]
    v_pk_mul_f32 v[228:229], v[228:229], s[48:49]
    v_pk_mul_f32 v[230:231], v[230:231], s[48:49]
    v_pk_mul_f32 v[232:233], v[232:233], s[48:49]
    v_pk_mul_f32 v[234:235], v[234:235], s[48:49]
    v_pk_mul_f32 v[236:237], v[236:237], s[48:49]
    v_pk_mul_f32 v[238:239], v[238:239], s[48:49]
    v_pk_mul_f32 v[240:241], v[240:241], s[48:49]
    v_pk_mul_f32 v[242:243], v[242:243], s[48:49]
    v_pk_mul_f32 v[244:245], v[244:245], s[48:49]
    v_pk_mul_f32 v[246:247], v[246:247], s[48:49]
    v_pk_mul_f32 v[248:249], v[248:249], s[48:49]
    v_pk_mul_f32 v[250:251], v[250:251], s[48:49]
    v_cvt_pk_bf16_f32 v224, v224, v225
    ds_write_b32 v0, v224 offset:0
    v_cvt_pk_bf16_f32 v226, v226, v227
    ds_write_b32 v0, v226 offset:512
    v_cvt_pk_bf16_f32 v228, v228, v229
    ds_write_b32 v0, v228 offset:2048
    v_cvt_pk_bf16_f32 v230, v230, v231
    ds_write_b32 v0, v230 offset:2560
    v_cvt_pk_bf16_f32 v232, v232, v233
    ds_write_b32 v0, v232 offset:4096
    v_cvt_pk_bf16_f32 v234, v234, v235
    ds_write_b32 v0, v234 offset:4608
    v_cvt_pk_bf16_f32 v236, v236, v237
    ds_write_b32 v0, v236 offset:6144
    buffer_load_dwordx4 v[188:191], v5, s[8:11], s61 offen offset:3072
    v_cvt_pk_bf16_f32 v238, v238, v239
    ds_write_b32 v0, v238 offset:6656
    s_add_u32 s61, s60, 8192
    buffer_load_dwordx4 v[96:99], v5, s[8:11], s61 offen offset:0
    v_cvt_pk_bf16_f32 v240, v240, v241
    ds_write_b32 v0, v240 offset:8192
    buffer_load_dwordx4 v[100:103], v5, s[8:11], s61 offen offset:1024
    v_cvt_pk_bf16_f32 v242, v242, v243
    ds_write_b32 v0, v242 offset:8704
    buffer_load_dwordx4 v[104:107], v5, s[8:11], s61 offen offset:2048
    v_cvt_pk_bf16_f32 v244, v244, v245
    ds_write_b32 v0, v244 offset:10240
    buffer_load_dwordx4 v[108:111], v5, s[8:11], s61 offen offset:3072
    v_cvt_pk_bf16_f32 v246, v246, v247
    ds_write_b32 v0, v246 offset:10752
    s_add_u32 s61, s60, 12288
    buffer_load_dwordx4 v[112:115], v5, s[8:11], s61 offen offset:0
    v_cvt_pk_bf16_f32 v248, v248, v249
    ds_write_b32 v0, v248 offset:12288
    buffer_load_dwordx4 v[116:119], v5, s[8:11], s61 offen offset:1024
    v_cvt_pk_bf16_f32 v250, v250, v251
    ds_write_b32 v0, v250 offset:12800
    buffer_load_dwordx4 v[120:123], v5, s[8:11], s61 offen offset:2048
    buffer_load_dwordx4 v[124:127], v5, s[8:11], s61 offen offset:3072
    s_add_u32 s61, s60, 16384
    buffer_load_dwordx4 v[128:131], v5, s[8:11], s61 offen offset:0
    buffer_load_dwordx4 v[132:135], v5, s[8:11], s61 offen offset:1024
    buffer_load_dwordx4 v[136:139], v5, s[8:11], s61 offen offset:2048
    buffer_load_dwordx4 v[192:195], v5, s[12:15], s56 offen offset:0
    buffer_load_dwordx4 v[196:199], v5, s[12:15], s56 offen offset:1024
    buffer_load_dwordx4 v[200:203], v5, s[12:15], s56 offen offset:2048
    buffer_load_dwordx4 v[204:207], v5, s[12:15], s56 offen offset:3072
    buffer_load_dwordx4 v[208:211], v5, s[12:15], s57 offen offset:0
    buffer_load_dwordx4 v[212:215], v5, s[12:15], s57 offen offset:1024
    buffer_load_dwordx4 v[216:219], v5, s[12:15], s57 offen offset:2048
    buffer_load_dwordx4 v[220:223], v5, s[12:15], s57 offen offset:3072
    s_add_u32 s61, s60, 79616
    v_add_u32 v1, s61, v5
    s_waitcnt vmcnt(26)
    ds_write_b128 v1, v[160:163] offset:0
    s_waitcnt vmcnt(25)
    ds_write_b128 v1, v[164:167] offset:1024
    s_waitcnt vmcnt(24)
    ds_write_b128 v1, v[168:171] offset:2048
    s_waitcnt vmcnt(23)
    ds_write_b128 v1, v[172:175] offset:3072
    s_waitcnt vmcnt(22)
    ds_write_b128 v1, v[176:179] offset:4096
    s_waitcnt vmcnt(21)
    ds_write_b128 v1, v[180:183] offset:5120
    s_waitcnt vmcnt(20)
    ds_write_b128 v1, v[184:187] offset:6144
    s_waitcnt vmcnt(19)
    ds_write_b128 v1, v[188:191] offset:7168
K2_PAD11:
    s_cbranch_execz K1_PADLINK12
    s_waitcnt lgkmcnt(0)
    s_barrier
    s_setprio 2
    s_waitcnt vmcnt(18)
    ds_write_b128 v1, v[96:99] offset:8192
    s_waitcnt vmcnt(17)
    ds_write_b128 v1, v[100:103] offset:9216
    s_waitcnt vmcnt(16)
    ds_write_b128 v1, v[104:107] offset:10240
    s_waitcnt vmcnt(15)
    ds_write_b128 v1, v[108:111] offset:11264
    s_waitcnt vmcnt(14)
    ds_write_b128 v1, v[112:115] offset:12288
    s_waitcnt vmcnt(13)
    ds_write_b128 v1, v[116:119] offset:13312
    s_waitcnt vmcnt(12)
    ds_write_b128 v1, v[120:123] offset:14336
    s_waitcnt vmcnt(11)
    ds_write_b128 v1, v[124:127] offset:15360
    s_waitcnt vmcnt(10)
    ds_write_b128 v1, v[128:131] offset:16384
    s_waitcnt vmcnt(9)
    ds_write_b128 v1, v[132:135] offset:17408
    s_waitcnt vmcnt(8)
    ds_write_b128 v1, v[136:139] offset:18432
    ds_write_b32 v91, v93 offset:560
    ds_read_b128 v[128:131], v56 offset:19456
    ds_read_b128 v[132:135], v56 offset:27648
    ds_read_b128 v[136:139], v57 offset:19456
    ds_read_b128 v[140:143], v57 offset:27648
    ds_read_b128 v[144:147], v58 offset:19456
    ds_read_b128 v[148:151], v58 offset:27648
    ds_read_b128 v[152:155], v59 offset:19456
    ds_read_b128 v[156:159], v59 offset:27648
    s_waitcnt vmcnt(7) lgkmcnt(7)
    v_mfma_f32_32x32x16_bf16 v[160:175], v[128:131], v[192:195], 0
    ds_read_b128 v[128:131], v60 offset:19456
    s_waitcnt lgkmcnt(7)
    v_mfma_f32_32x32x16_bf16 v[176:191], v[132:135], v[192:195], 0
    ds_read_b128 v[132:135], v60 offset:27648
    s_waitcnt vmcnt(6) lgkmcnt(7)
    v_mfma_f32_32x32x16_bf16 v[160:175], v[136:139], v[196:199], v[160:175]
    ds_read_b128 v[136:139], v61 offset:19456
    s_waitcnt lgkmcnt(7)
    v_mfma_f32_32x32x16_bf16 v[176:191], v[140:143], v[196:199], v[176:191]
    ds_read_b128 v[140:143], v61 offset:27648
    s_waitcnt vmcnt(5) lgkmcnt(7)
    v_mfma_f32_32x32x16_bf16 v[160:175], v[144:147], v[200:203], v[160:175]
    ds_read_b128 v[144:147], v62 offset:19456
    s_waitcnt lgkmcnt(7)
    v_mfma_f32_32x32x16_bf16 v[176:191], v[148:151], v[200:203], v[176:191]
    ds_read_b128 v[148:151], v62 offset:27648
    s_waitcnt vmcnt(4) lgkmcnt(7)
    v_mfma_f32_32x32x16_bf16 v[160:175], v[152:155], v[204:207], v[160:175]
    ds_read_b128 v[152:155], v63 offset:19456
    s_waitcnt lgkmcnt(7)
    v_mfma_f32_32x32x16_bf16 v[176:191], v[156:159], v[204:207], v[176:191]
    ds_read_b128 v[156:159], v63 offset:27648
    s_waitcnt vmcnt(3) lgkmcnt(7)
    v_mfma_f32_32x32x16_bf16 v[160:175], v[128:131], v[208:211], v[160:175]
    s_waitcnt lgkmcnt(6)
    v_mfma_f32_32x32x16_bf16 v[176:191], v[132:135], v[208:211], v[176:191]
    s_waitcnt vmcnt(2) lgkmcnt(5)
    v_mfma_f32_32x32x16_bf16 v[160:175], v[136:139], v[212:215], v[160:175]
    s_waitcnt lgkmcnt(4)
    v_mfma_f32_32x32x16_bf16 v[176:191], v[140:143], v[212:215], v[176:191]
    s_waitcnt vmcnt(1) lgkmcnt(3)
    v_mfma_f32_32x32x16_bf16 v[160:175], v[144:147], v[216:219], v[160:175]
    s_waitcnt lgkmcnt(2)
    v_mfma_f32_32x32x16_bf16 v[176:191], v[148:151], v[216:219], v[176:191]
    s_waitcnt vmcnt(0) lgkmcnt(1)
    v_mfma_f32_32x32x16_bf16 v[160:175], v[152:155], v[220:223], v[160:175]
    s_waitcnt lgkmcnt(0)
    v_mfma_f32_32x32x16_bf16 v[176:191], v[156:159], v[220:223], v[176:191]
    s_mov_b32 s48, 3216517457
K2_BJOIN:
    ds_read_b32 v11, v10 offset:768
    ds_read_b32 v3, v10 offset:256
    ds_read_b32 v94, v94 offset:768
    v_mfma_f32_32x32x16_bf16 v[192:207], v[28:31], v[28:31], 0
    s_add_u32 s56, s37, 513
    s_mov_b32 s50, s48
    s_waitcnt lgkmcnt(1)
    v_readlane_b32 s48, v11, 63
    v_cmp_lt_u32 s[54:55], s56, v3
    s_and_b32 s48, s48, 0x1fff
    s_lshr_b32 s34, s55, 24
    s_add_u32 s49, s48, 15
    s_lshr_b32 s49, s49, 4
    s_mul_i32 s40, s49, s26
    s_add_u32 s41, s40, s49
    s_lshr_b32 s40, s40, 3
    s_lshr_b32 s41, s41, 3
    s_lshl_b32 s56, s40, 7
    v_add_u32 v14, s56, v14
    v_add_u32 v15, s56, v15
    v_add_u32 v13, s56, v13
    v_lshl_add_u32 v0, v22, 3, s56
    ds_read_u16 v16, v14
    ds_read_u16 v210, v14 offset:128
    v_mov_b32 v211, v17
    ds_read_u8 v48, v15 offset:2
    ds_read_u8 v52, v15 offset:130
    ds_read2_b32 v[218:219], v13 offset0:32 offset1:0
    s_waitcnt lgkmcnt(4)
    buffer_load_dwordx4 v[96:99], v[16:17], s[16:19], 0 idxen offen offset:0
    buffer_load_dwordx4 v[100:103], v[16:17], s[16:19], 0 idxen offen offset:64
    buffer_load_dwordx4 v[104:107], v[16:17], s[16:19], 0 idxen offen offset:128
    buffer_load_dwordx4 v[108:111], v[16:17], s[16:19], 0 idxen offen offset:192
    s_waitcnt lgkmcnt(1)
    ds_read_b128 v[48:51], v48 offset:0
    ds_read_b128 v[52:55], v52 offset:0
    ds_read_u16 v16, v14 offset:256
    ds_read_u8 v216, v15 offset:258
    s_mov_b32 s51, s50
    v_pk_mul_f32 v[160:161], v[160:161], s[50:51]
    v_pk_mul_f32 v[162:163], v[162:163], s[50:51]
    v_pk_mul_f32 v[164:165], v[164:165], s[50:51]
    v_pk_mul_f32 v[166:167], v[166:167], s[50:51]
    v_pk_mul_f32 v[168:169], v[168:169], s[50:51]
    v_pk_mul_f32 v[170:171], v[170:171], s[50:51]
    v_pk_mul_f32 v[172:173], v[172:173], s[50:51]
    v_pk_mul_f32 v[174:175], v[174:175], s[50:51]
    v_pk_mul_f32 v[176:177], v[176:177], s[50:51]
    v_pk_mul_f32 v[178:179], v[178:179], s[50:51]
    v_pk_mul_f32 v[180:181], v[180:181], s[50:51]
    v_pk_mul_f32 v[182:183], v[182:183], s[50:51]
    v_pk_mul_f32 v[184:185], v[184:185], s[50:51]
    v_mov_b64 v[188:189], 0
    v_mov_b64 v[190:191], 0
    s_branch K2_SETUP
K2_PAD12:
    s_branch K1_PADLINK13
K2_JOB67:
    s_cmp_eq_u32 s3, 7
    s_cbranch_scc1 K2_JOB7
    s_mov_b32 m0, 4096
    s_mov_b32 s58, 3309568
    buffer_load_dwordx4 v5, s[12:15], s58 offen lds
    s_branch K2_JOBRET
K2_JOB7:
    s_mul_i32 s58, s2, 294
    v_mul_u32_u24 v1, 6, v22
    v_mov_b64 v[20:21], 0
    s_mov_b32 exec_hi, 131071
    buffer_load_dwordx2 v[20:21], v1, s[8:11], s58 offen
    s_mov_b32 exec_hi, -1
    s_branch K2_JOBRET
K2_BSKIP:
    s_waitcnt lgkmcnt(0)
    s_barrier
    s_add_u32 s16, s12, 4194304
    s_addc_u32 s17, s13, 0
    s_or_b32 s17, s17, 16777216
    s_mov_b32 s18, 12500
    s_mov_b32 s19, 131072
    v_lshlrev_b32 v48, 1, v10
    v_and_b32 v49, 496, v5
    ds_read_b32 v40, v48 offset:4096
    ds_read_b32 v44, v48 offset:4100
    ds_read_b128 v[24:27], v49 offset:4608
    ds_write_b32 v91, v93 offset:560
    s_mov_b32 s48, 1.0
    s_barrier
    s_branch K2_BJOIN
K2_PAD13:
    s_branch K1_PADEND
K2_OTH:
    s_cmp_lg_u32 s33, s42
    s_cbranch_scc1 K2_EVS
K2_SYNC:
    ds_read_b32 v0, v10 offset:640
    s_waitcnt lgkmcnt(0)
    v_cmp_ne_u32 vcc, 0, v0
    s_cmp_eq_u32 vcc_lo, 0xff
    s_cbranch_scc0 K2_SYNC
    s_mov_b32 s33, -1
    s_cmp_eq_u32 s35, 2
    s_cbranch_scc1 K2_SYNCED
K2_EVS:
    s_cmp_lg_u32 s38, s42
    s_cbranch_scc1 K2_EVP
    s_mov_b32 s38, -1
    s_setprio 1
    s_cmp_lt_u32 s3, 4
    s_cbranch_scc1 K2_EVP
    s_setprio 0
K2_EVP:
    s_sub_u32 s47, s43, 1
    s_cmp_lg_u32 s47, s42
    s_cbranch_scc1 K2_EVB
    s_lshl_b32 s58, s43, 4
    v_cmp_ge_u32 vcc, s58, v11
    s_bcnt1_i32_b64 s57, vcc
    v_readlane_b32 s48, v6, s57
    s_bfe_u32 s52, s48, 327680
    v_lshl_add_u32 v1, s52, 9, v10
    ds_read_b32 v41, v1 offset:5120
    ds_read_b32 v45, v1 offset:5376
    s_bfe_u32 s52, s48, 327685
    v_lshl_add_u32 v2, s52, 9, v10
    ds_read_b32 v42, v2 offset:5120
    ds_read_b32 v46, v2 offset:5376
    s_bfe_u32 s52, s48, 327690
    v_lshl_add_u32 v3, s52, 9, v10
    ds_read_b32 v43, v3 offset:5120
    ds_read_b32 v47, v3 offset:5376
    s_lshr_b32 s43, s48, 22
    s_sub_u32 s47, s43, 1
K2_EVB:
    s_min_u32 s47, s47, s38
    s_min_u32 s47, s47, s33
    s_min_u32 s47, s47, s41
    s_not_b32 s40, s42
    s_min_u32 s42, s47, s44
    s_add_u32 s40, s40, s42
    s_cmp_eq_u32 s35, 0
    s_cbranch_scc1 K2_RET0
    s_cmp_eq_u32 s35, 1
    s_cbranch_scc1 K2_RET1
    s_cmp_eq_u32 s35, 3
    s_cbranch_scc1 K2S_RET0
    s_branch K2S_RET1
K2_FILL:
    v_add_lshl_u32 v1, v11, s3, 3
    s_add_u32 s49, s3, 12
    v_cmpx_ge_u32 vcc, s49, v3
    ds_write_b64 v1, v[166:167] offset:33888
    s_add_u32 s49, s3, 8
    v_cmpx_ge_u32 vcc, s49, v3
    ds_write_b64 v1, v[166:167] offset:33856
    s_add_u32 s49, s3, 4
    v_cmpx_ge_u32 vcc, s49, v3
    ds_write_b64 v1, v[166:167] offset:33824
    s_add_u32 s49, s3, 0
    v_cmpx_ge_u32 vcc, s49, v3
    ds_write_b64 v1, v[166:167] offset:33792
    s_mov_b64 exec, -1
    s_branch K2_FILLED
K2_MORE:
    s_waitcnt vmcnt(0) lgkmcnt(0)
    s_barrier
    s_setprio 0
    s_add_u32 s37, s37, 512
    v_lshlrev_b32 v5, 4, v22
    s_cmp_lg_u32 vcc_lo, 0
    s_cbranch_scc1 K2_REDO
    s_cmp_lt_u32 s3, 4
    s_cbranch_scc1 K2_AGAIN
    s_mul_i32 s60, s69, 19456
    s_add_u32 m0, s60, 79616
    s_add_u32 s61, s60, 0
    buffer_load_dwordx4 v5, s[8:11], s61 offen offset:0 lds
    buffer_load_dwordx4 v5, s[8:11], s61 offen offset:1024 lds
    buffer_load_dwordx4 v5, s[8:11], s61 offen offset:2048 lds
    buffer_load_dwordx4 v5, s[8:11], s61 offen offset:3072 lds
    s_add_u32 m0, s60, 83712
    s_add_u32 s61, s60, 4096
    buffer_load_dwordx4 v5, s[8:11], s61 offen offset:0 lds
    buffer_load_dwordx4 v5, s[8:11], s61 offen offset:1024 lds
    buffer_load_dwordx4 v5, s[8:11], s61 offen offset:2048 lds
    buffer_load_dwordx4 v5, s[8:11], s61 offen offset:3072 lds
    s_add_u32 m0, s60, 87808
    s_add_u32 s61, s60, 8192
    buffer_load_dwordx4 v5, s[8:11], s61 offen offset:0 lds
    buffer_load_dwordx4 v5, s[8:11], s61 offen offset:1024 lds
    buffer_load_dwordx4 v5, s[8:11], s61 offen offset:2048 lds
    buffer_load_dwordx4 v5, s[8:11], s61 offen offset:3072 lds
    s_add_u32 m0, s60, 91904
    s_add_u32 s61, s60, 12288
    buffer_load_dwordx4 v5, s[8:11], s61 offen offset:0 lds
    buffer_load_dwordx4 v5, s[8:11], s61 offen offset:1024 lds
    buffer_load_dwordx4 v5, s[8:11], s61 offen offset:2048 lds
    buffer_load_dwordx4 v5, s[8:11], s61 offen offset:3072 lds
    s_add_u32 m0, s60, 96000
    s_add_u32 s61, s60, 16384
    buffer_load_dwordx4 v5, s[8:11], s61 offen offset:0 lds
    buffer_load_dwordx4 v5, s[8:11], s61 offen offset:1024 lds
    buffer_load_dwordx4 v5, s[8:11], s61 offen offset:2048 lds
    s_waitcnt vmcnt(0)
    s_branch K2_AGAIN
K2_OVER:
    v_lshlrev_b32_e64 v0, 2, s3
    v_mov_b32 v1, 2
    ds_write_b32 v0, v1 offset:640
    s_branch K2_OVERRET
K2_REDO:
    s_load_dwordx2 s[4:5], s[0:1], 0
    s_mov_b32 s37, 0
    s_mov_b32 s24, 805306368
    s_mov_b32 s25, 805306368
    s_mov_b32 s31, 805306368
    v_mov_b64 v[188:189], 0
    s_branch K2_AGAIN
K2S_ENTER:
    v_lshlrev_b32 v0, 2, v10
    v_and_b32 v0, 496, v0
    ds_read_b128 v[24:27], v0 offset:4608
    s_waitcnt lgkmcnt(0)
    v_mul_f32 v24, s31, v24
    v_mul_f32 v25, s31, v25
    v_mul_f32 v26, s31, v26
    v_mul_f32 v27, s31, v27
    s_nop 11
.p2align 3
K2S_LOOP:
    v_mfma_f32_32x32x16_bf16 v[144:159], v[104:107], v[32:35], 0
    v_exp_f32 v80, v128
    v_exp_f32 v81, v129
    v_exp_f32_e64 v82, v130
    v_mfma_f32_32x32x16_bf16 v[144:159], v[108:111], v[36:39], v[144:159]
    v_exp_f32 v83, v131
    v_exp_f32 v84, v132
    v_exp_f32_e64 v85, v133
    v_mfma_f32_32x32x16_bf16 v[144:159], v[48:51], v[44:47], v[144:159]
    v_exp_f32 v86, v134
    v_exp_f32 v87, v135
    v_exp_f32_e64 v88, v136
    v_smfmac_f32_16x16x64_bf16 v[200:203], v[28:31], v[64:71], v9
    v_exp_f32 v89, v137
    v_exp_f32 v90, v138
    v_exp_f32 v91, v139
    v_exp_f32 v92, v140
    v_exp_f32 v93, v141
    v_exp_f32 v94, v142
    v_exp_f32_e64 v95, v143
    v_pk_fma_f32 v[80:81], v[80:81], s[24:25], s[24:25] clamp
    v_pk_fma_f32 v[82:83], v[82:83], s[24:25], s[24:25] clamp
    v_pk_fma_f32 v[84:85], v[84:85], s[24:25], s[24:25] clamp
    v_pk_fma_f32 v[86:87], v[86:87], s[24:25], s[24:25] clamp
    v_pk_fma_f32 v[88:89], v[88:89], s[24:25], s[24:25] clamp
    v_pk_fma_f32 v[90:91], v[90:91], s[24:25], s[24:25] clamp
    v_pk_fma_f32 v[92:93], v[92:93], s[24:25], s[24:25] clamp
    v_pk_fma_f32 v[94:95], v[94:95], s[24:25], s[24:25] clamp
    v_pk_mul_f32 v[56:57], v[80:81], v[82:83]
    v_pk_mul_f32 v[58:59], v[84:85], v[86:87]
    v_pk_mul_f32 v[60:61], v[88:89], v[90:91]
    v_pk_mul_f32 v[62:63], v[92:93], v[94:95]
    v_pk_mul_f32 v[20:21], v[56:57], v[58:59]
    v_pk_mul_f32 v[22:23], v[60:61], v[62:63]
    v_pk_mul_f32 v[82:83], v[128:129], v[82:83]
    v_pk_mul_f32 v[80:81], v[80:81], v[130:131]
    v_pk_mul_f32 v[86:87], v[132:133], v[86:87]
    v_pk_mul_f32 v[84:85], v[84:85], v[134:135]
    v_pk_mul_f32 v[90:91], v[136:137], v[90:91]
    v_pk_mul_f32 v[88:89], v[88:89], v[138:139]
    v_pk_mul_f32 v[94:95], v[140:141], v[94:95]
    v_pk_mul_f32 v[92:93], v[92:93], v[142:143]
    v_smfmac_f32_16x16x64_bf16 v[204:207], v[28:31], v[72:79], v9
    v_rcp_f32 v20, v20
    v_rcp_f32 v21, v21
    v_rcp_f32 v22, v22
    v_rcp_f32 v23, v23
    v_pk_mul_f32 v[56:57], v[56:57], v[20:21]
    v_pk_mul_f32 v[58:59], v[58:59], v[20:21]
    v_pk_mul_f32 v[60:61], v[60:61], v[22:23]
    v_pk_mul_f32 v[62:63], v[62:63], v[22:23]
    v_pk_mul_f32 v[64:65], v[82:83], v[58:59]
    v_pk_mul_f32 v[72:73], v[80:81], v[58:59]
    v_pk_mul_f32 v[66:67], v[86:87], v[56:57]
    v_pk_mul_f32 v[74:75], v[84:85], v[56:57]
    v_pk_mul_f32 v[68:69], v[90:91], v[62:63]
    v_pk_mul_f32 v[76:77], v[88:89], v[62:63]
    v_pk_mul_f32 v[70:71], v[94:95], v[60:61]
    v_pk_mul_f32 v[78:79], v[92:93], v[60:61]
    v_add_u32 v14, s64, v14
    s_sub_u32 s40, s40, 1
    s_cbranch_scc1 K2S_EVT0
K2S_RET0:
    s_waitcnt vmcnt(0) lgkmcnt(0)
    buffer_load_dwordx4 v[96:99], v[16:17], s[16:19], 0 idxen offen offset:0
    buffer_load_dwordx4 v[100:103], v[16:17], s[16:19], 0 idxen offen offset:64
    buffer_load_dwordx4 v[104:107], v[16:17], s[16:19], 0 idxen offen offset:128
    buffer_load_dwordx4 v[108:111], v[16:17], s[16:19], 0 idxen offen offset:192
    ds_read_b128 v[48:51], v216 offset:0
    ds_read_b32 v48, v15 offset:260
    ds_read_u8 v216, v15 offset:386
    ds_read_u16 v16, v14 offset:256
    ds_read_b64_tr_b16 v[28:29], v18 offset:23168
    ds_read_b64_tr_b16 v[30:31], v19 offset:23168
    ds_read_b32 v218, v13 offset:384
    v_mfma_f32_32x32x16_bf16 v[128:143], v[112:115], v[32:35], 0
    v_exp_f32 v80, v144
    v_exp_f32 v81, v145
    v_exp_f32_e64 v82, v146
    v_mfma_f32_32x32x16_bf16 v[128:143], v[116:119], v[36:39], v[128:143]
    v_exp_f32 v83, v147
    v_exp_f32 v84, v148
    v_exp_f32_e64 v85, v149
    v_mfma_f32_32x32x16_bf16 v[128:143], v[52:55], v[40:43], v[128:143]
    v_exp_f32 v86, v150
    v_exp_f32 v87, v151
    v_exp_f32_e64 v88, v152
    v_smfmac_f32_16x16x64_bf16 v[192:195], v[212:215], v[64:71], v9
    v_exp_f32 v89, v153
    v_exp_f32 v90, v154
    v_exp_f32 v91, v155
    v_exp_f32 v92, v156
    v_exp_f32 v93, v157
    v_exp_f32 v94, v158
    v_exp_f32_e64 v95, v159
    v_pk_fma_f32 v[80:81], v[80:81], s[24:25], s[24:25] clamp
    v_pk_fma_f32 v[82:83], v[82:83], s[24:25], s[24:25] clamp
    v_pk_fma_f32 v[84:85], v[84:85], s[24:25], s[24:25] clamp
    v_pk_fma_f32 v[86:87], v[86:87], s[24:25], s[24:25] clamp
    v_pk_fma_f32 v[88:89], v[88:89], s[24:25], s[24:25] clamp
    v_pk_fma_f32 v[90:91], v[90:91], s[24:25], s[24:25] clamp
    v_pk_fma_f32 v[92:93], v[92:93], s[24:25], s[24:25] clamp
    v_pk_fma_f32 v[94:95], v[94:95], s[24:25], s[24:25] clamp
    v_pk_mul_f32 v[56:57], v[80:81], v[82:83]
    v_pk_mul_f32 v[58:59], v[84:85], v[86:87]
    v_pk_mul_f32 v[60:61], v[88:89], v[90:91]
    v_pk_mul_f32 v[62:63], v[92:93], v[94:95]
    v_pk_mul_f32 v[20:21], v[56:57], v[58:59]
    v_pk_mul_f32 v[22:23], v[60:61], v[62:63]
    v_pk_mul_f32 v[82:83], v[144:145], v[82:83]
    v_pk_mul_f32 v[80:81], v[80:81], v[146:147]
    v_pk_mul_f32 v[86:87], v[148:149], v[86:87]
    v_pk_mul_f32 v[84:85], v[84:85], v[150:151]
    v_pk_mul_f32 v[90:91], v[152:153], v[90:91]
    v_pk_mul_f32 v[88:89], v[88:89], v[154:155]
    v_pk_mul_f32 v[94:95], v[156:157], v[94:95]
    v_pk_mul_f32 v[92:93], v[92:93], v[158:159]
    v_smfmac_f32_16x16x64_bf16 v[196:199], v[212:215], v[72:79], v9
    v_rcp_f32 v20, v20
    v_rcp_f32 v21, v21
    v_rcp_f32 v22, v22
    v_rcp_f32 v23, v23
    v_and_or_b32 v18, v219, v12, v13
    v_and_or_b32 v19, v219, v209, v13
    v_pk_mul_f32 v[56:57], v[56:57], v[20:21]
    v_pk_mul_f32 v[58:59], v[58:59], v[20:21]
    v_pk_mul_f32 v[60:61], v[60:61], v[22:23]
    v_pk_mul_f32 v[62:63], v[62:63], v[22:23]
    v_pk_mul_f32 v[64:65], v[82:83], v[58:59]
    v_pk_mul_f32 v[72:73], v[80:81], v[58:59]
    v_pk_mul_f32 v[66:67], v[86:87], v[56:57]
    v_pk_mul_f32 v[74:75], v[84:85], v[56:57]
    v_pk_mul_f32 v[68:69], v[90:91], v[62:63]
    v_pk_mul_f32 v[76:77], v[88:89], v[62:63]
    v_pk_mul_f32 v[70:71], v[94:95], v[60:61]
    v_pk_mul_f32 v[78:79], v[92:93], v[60:61]
    v_mfma_f32_32x32x16_bf16 v[144:159], v[120:123], v[32:35], 0
    v_exp_f32 v80, v128
    v_exp_f32 v81, v129
    v_exp_f32_e64 v82, v130
    v_mfma_f32_32x32x16_bf16 v[144:159], v[124:127], v[36:39], v[144:159]
    v_exp_f32 v83, v131
    v_exp_f32 v84, v132
    v_exp_f32_e64 v85, v133
    v_mfma_f32_32x32x16_bf16 v[144:159], v[52:55], v[44:47], v[144:159]
    v_exp_f32 v86, v134
    v_exp_f32 v87, v135
    v_exp_f32_e64 v88, v136
    v_smfmac_f32_16x16x64_bf16 v[200:203], v[212:215], v[64:71], v9
    v_exp_f32 v89, v137
    v_exp_f32 v90, v138
    v_exp_f32 v91, v139
    v_exp_f32 v92, v140
    v_exp_f32 v93, v141
    v_exp_f32 v94, v142
    v_exp_f32_e64 v95, v143
    v_pk_fma_f32 v[80:81], v[80:81], s[24:25], s[24:25] clamp
    v_pk_fma_f32 v[82:83], v[82:83], s[24:25], s[24:25] clamp
    v_pk_fma_f32 v[84:85], v[84:85], s[24:25], s[24:25] clamp
    v_pk_fma_f32 v[86:87], v[86:87], s[24:25], s[24:25] clamp
    v_pk_fma_f32 v[88:89], v[88:89], s[24:25], s[24:25] clamp
    v_pk_fma_f32 v[90:91], v[90:91], s[24:25], s[24:25] clamp
    v_pk_fma_f32 v[92:93], v[92:93], s[24:25], s[24:25] clamp
    v_pk_fma_f32 v[94:95], v[94:95], s[24:25], s[24:25] clamp
    v_pk_mul_f32 v[56:57], v[80:81], v[82:83]
    v_pk_mul_f32 v[58:59], v[84:85], v[86:87]
    v_pk_mul_f32 v[60:61], v[88:89], v[90:91]
    v_pk_mul_f32 v[62:63], v[92:93], v[94:95]
    v_pk_mul_f32 v[20:21], v[56:57], v[58:59]
    v_pk_mul_f32 v[22:23], v[60:61], v[62:63]
    v_pk_mul_f32 v[82:83], v[128:129], v[82:83]
    v_pk_mul_f32 v[80:81], v[80:81], v[130:131]
    v_pk_mul_f32 v[86:87], v[132:133], v[86:87]
    v_pk_mul_f32 v[84:85], v[84:85], v[134:135]
    v_pk_mul_f32 v[90:91], v[136:137], v[90:91]
    v_pk_mul_f32 v[88:89], v[88:89], v[138:139]
    v_pk_mul_f32 v[94:95], v[140:141], v[94:95]
    v_pk_mul_f32 v[92:93], v[92:93], v[142:143]
    v_smfmac_f32_16x16x64_bf16 v[204:207], v[212:215], v[72:79], v9
    v_rcp_f32 v20, v20
    v_rcp_f32 v21, v21
    v_rcp_f32 v22, v22
    v_rcp_f32 v23, v23
    v_pk_mul_f32 v[56:57], v[56:57], v[20:21]
    v_pk_mul_f32 v[58:59], v[58:59], v[20:21]
    v_pk_mul_f32 v[60:61], v[60:61], v[22:23]
    v_pk_mul_f32 v[62:63], v[62:63], v[22:23]
    v_pk_mul_f32 v[64:65], v[82:83], v[58:59]
    v_pk_mul_f32 v[72:73], v[80:81], v[58:59]
    v_pk_mul_f32 v[66:67], v[86:87], v[56:57]
    v_pk_mul_f32 v[74:75], v[84:85], v[56:57]
    v_pk_mul_f32 v[68:69], v[90:91], v[62:63]
    v_pk_mul_f32 v[76:77], v[88:89], v[62:63]
    v_pk_mul_f32 v[70:71], v[94:95], v[60:61]
    v_pk_mul_f32 v[78:79], v[92:93], v[60:61]
    v_add_u32 v15, s64, v15
    s_sub_u32 s40, s40, 1
    s_cbranch_scc1 K2S_EVT1
K2S_RET1:
    s_waitcnt vmcnt(0) lgkmcnt(0)
    buffer_load_dwordx4 v[112:115], v[210:211], s[16:19], 0 idxen offen offset:0
    buffer_load_dwordx4 v[116:119], v[210:211], s[16:19], 0 idxen offen offset:64
    buffer_load_dwordx4 v[120:123], v[210:211], s[16:19], 0 idxen offen offset:128
    buffer_load_dwordx4 v[124:127], v[210:211], s[16:19], 0 idxen offen offset:192
    ds_read_b128 v[52:55], v216 offset:0
    ds_read_b32 v52, v15 offset:132
    ds_read_u8 v216, v15 offset:258
    ds_read_u16 v210, v14 offset:384
    ds_read_b64_tr_b16 v[212:213], v18 offset:23296
    ds_read_b64_tr_b16 v[214:215], v19 offset:23296
    ds_read_b32 v219, v13 offset:512
    v_mfma_f32_32x32x16_bf16 v[128:143], v[96:99], v[32:35], 0
    v_exp_f32 v80, v144
    v_exp_f32 v81, v145
    v_exp_f32_e64 v82, v146
    v_mfma_f32_32x32x16_bf16 v[128:143], v[100:103], v[36:39], v[128:143]
    v_exp_f32 v83, v147
    v_exp_f32 v84, v148
    v_exp_f32_e64 v85, v149
    v_mfma_f32_32x32x16_bf16 v[128:143], v[48:51], v[40:43], v[128:143]
    v_exp_f32 v86, v150
    v_exp_f32 v87, v151
    v_exp_f32_e64 v88, v152
    v_smfmac_f32_16x16x64_bf16 v[192:195], v[28:31], v[64:71], v9
    v_exp_f32 v89, v153
    v_exp_f32 v90, v154
    v_exp_f32 v91, v155
    v_exp_f32 v92, v156
    v_exp_f32 v93, v157
    v_exp_f32 v94, v158
    v_exp_f32_e64 v95, v159
    v_pk_fma_f32 v[80:81], v[80:81], s[24:25], s[24:25] clamp
    v_pk_fma_f32 v[82:83], v[82:83], s[24:25], s[24:25] clamp
    v_pk_fma_f32 v[84:85], v[84:85], s[24:25], s[24:25] clamp
    v_pk_fma_f32 v[86:87], v[86:87], s[24:25], s[24:25] clamp
    v_pk_fma_f32 v[88:89], v[88:89], s[24:25], s[24:25] clamp
    v_pk_fma_f32 v[90:91], v[90:91], s[24:25], s[24:25] clamp
    v_pk_fma_f32 v[92:93], v[92:93], s[24:25], s[24:25] clamp
    v_pk_fma_f32 v[94:95], v[94:95], s[24:25], s[24:25] clamp
    v_pk_mul_f32 v[56:57], v[80:81], v[82:83]
    v_pk_mul_f32 v[58:59], v[84:85], v[86:87]
    v_pk_mul_f32 v[60:61], v[88:89], v[90:91]
    v_pk_mul_f32 v[62:63], v[92:93], v[94:95]
    v_pk_mul_f32 v[20:21], v[56:57], v[58:59]
    v_pk_mul_f32 v[22:23], v[60:61], v[62:63]
    v_pk_mul_f32 v[82:83], v[144:145], v[82:83]
    v_pk_mul_f32 v[80:81], v[80:81], v[146:147]
    v_pk_mul_f32 v[86:87], v[148:149], v[86:87]
    v_pk_mul_f32 v[84:85], v[84:85], v[150:151]
    v_pk_mul_f32 v[90:91], v[152:153], v[90:91]
    v_pk_mul_f32 v[88:89], v[88:89], v[154:155]
    v_pk_mul_f32 v[94:95], v[156:157], v[94:95]
    v_pk_mul_f32 v[92:93], v[92:93], v[158:159]
    v_smfmac_f32_16x16x64_bf16 v[196:199], v[28:31], v[72:79], v9
    v_rcp_f32 v20, v20
    v_rcp_f32 v21, v21
    v_rcp_f32 v22, v22
    v_rcp_f32 v23, v23
    v_add_u32_e64 v13, s64, v13
    v_and_or_b32 v18, v218, v12, v13
    v_and_or_b32 v19, v218, v209, v13
    v_pk_mul_f32 v[56:57], v[56:57], v[20:21]
    v_pk_mul_f32 v[58:59], v[58:59], v[20:21]
    v_pk_mul_f32 v[60:61], v[60:61], v[22:23]
    v_pk_mul_f32 v[62:63], v[62:63], v[22:23]
    v_pk_mul_f32 v[64:65], v[82:83], v[58:59]
    v_pk_mul_f32 v[72:73], v[80:81], v[58:59]
    v_pk_mul_f32 v[66:67], v[86:87], v[56:57]
    v_pk_mul_f32 v[74:75], v[84:85], v[56:57]
    v_pk_mul_f32 v[68:69], v[90:91], v[62:63]
    v_pk_mul_f32 v[76:77], v[88:89], v[62:63]
    v_pk_mul_f32 v[70:71], v[94:95], v[60:61]
    v_pk_mul_f32 v[78:79], v[92:93], v[60:61]
    s_branch K2S_LOOP
.p2align 3
K2S_LAST0:
    s_waitcnt lgkmcnt(0)
    v_mov_b64 v[28:29], v[212:213]
    v_mov_b64 v[30:31], v[214:215]
K2S_LAST1:
    s_add_u32 s48, s46, 1
    s_waitcnt lgkmcnt(0)
    v_lshlrev_b32_e64 v16, 2, v10
    s_cmp_lt_u32 s3, 4
    s_cbranch_scc1 K2S_LAST2
    s_setprio 0
    buffer_load_dwordx4 v[96:99], v16, s[12:15], s92 offen offset:0
    buffer_load_dwordx4 v[100:103], v16, s[12:15], s92 offen offset:1024
    buffer_load_dwordx4 v[104:107], v16, s[12:15], s92 offen offset:2048
    buffer_load_dwordx4 v[108:111], v16, s[12:15], s92 offen offset:3072
    buffer_load_dwordx4 v[112:115], v16, s[12:15], s93 offen offset:0
    buffer_load_dwordx4 v[116:119], v16, s[12:15], s93 offen offset:1024
    buffer_load_dwordx4 v[120:123], v16, s[12:15], s93 offen offset:2048
    buffer_load_dwordx4 v[124:127], v16, s[12:15], s93 offen offset:3072
K2S_LAST2:
    v_exp_f32 v80, v144
    v_exp_f32 v81, v145
    v_exp_f32 v82, v146
    v_exp_f32 v83, v147
    v_exp_f32 v84, v148
    v_exp_f32 v85, v149
    v_exp_f32 v86, v150
    v_exp_f32 v87, v151
    v_exp_f32_e64 v88, v152
    v_smfmac_f32_16x16x64_bf16 v[192:195], v[28:31], v[64:71], v9
    v_exp_f32 v89, v153
    v_exp_f32 v90, v154
    v_exp_f32 v91, v155
    v_exp_f32 v92, v156
    v_exp_f32 v93, v157
    v_exp_f32 v94, v158
    v_exp_f32_e64 v95, v159
    v_pk_fma_f32 v[80:81], v[80:81], s[24:25], s[24:25] clamp
    v_pk_fma_f32 v[82:83], v[82:83], s[24:25], s[24:25] clamp
    v_pk_fma_f32 v[84:85], v[84:85], s[24:25], s[24:25] clamp
    v_pk_fma_f32 v[86:87], v[86:87], s[24:25], s[24:25] clamp
    v_pk_fma_f32 v[88:89], v[88:89], s[24:25], s[24:25] clamp
    v_pk_fma_f32 v[90:91], v[90:91], s[24:25], s[24:25] clamp
    v_pk_fma_f32 v[92:93], v[92:93], s[24:25], s[24:25] clamp
    v_pk_fma_f32 v[94:95], v[94:95], s[24:25], s[24:25] clamp
    v_pk_mul_f32 v[56:57], v[80:81], v[82:83]
    v_pk_mul_f32 v[58:59], v[84:85], v[86:87]
    v_pk_mul_f32 v[60:61], v[88:89], v[90:91]
    v_pk_mul_f32 v[62:63], v[92:93], v[94:95]
    v_pk_mul_f32 v[20:21], v[56:57], v[58:59]
    v_pk_mul_f32 v[22:23], v[60:61], v[62:63]
    v_pk_mul_f32 v[82:83], v[144:145], v[82:83]
    v_pk_mul_f32 v[80:81], v[80:81], v[146:147]
    v_pk_mul_f32 v[86:87], v[148:149], v[86:87]
    v_pk_mul_f32 v[84:85], v[84:85], v[150:151]
    v_pk_mul_f32 v[90:91], v[152:153], v[90:91]
    v_pk_mul_f32 v[88:89], v[88:89], v[154:155]
    v_pk_mul_f32 v[94:95], v[156:157], v[94:95]
    v_pk_mul_f32 v[92:93], v[92:93], v[158:159]
    v_smfmac_f32_16x16x64_bf16 v[196:199], v[28:31], v[72:79], v9
    v_rcp_f32 v20, v20
    v_rcp_f32 v21, v21
    v_rcp_f32 v22, v22
    v_rcp_f32 v23, v23
    v_pk_mul_f32 v[56:57], v[56:57], v[20:21]
    v_pk_mul_f32 v[58:59], v[58:59], v[20:21]
    v_pk_mul_f32 v[60:61], v[60:61], v[22:23]
    v_pk_mul_f32 v[62:63], v[62:63], v[22:23]
    v_pk_mul_f32 v[64:65], v[82:83], v[58:59]
    v_pk_mul_f32 v[72:73], v[80:81], v[58:59]
    v_pk_mul_f32 v[66:67], v[86:87], v[56:57]
    v_pk_mul_f32 v[74:75], v[84:85], v[56:57]
    v_pk_mul_f32 v[68:69], v[90:91], v[62:63]
    v_pk_mul_f32 v[76:77], v[88:89], v[62:63]
    v_pk_mul_f32 v[70:71], v[94:95], v[60:61]
    v_pk_mul_f32 v[78:79], v[92:93], v[60:61]
    s_branch K2S_DONE
.p2align 3
K2S_EVT0:
    s_cmp_lg_u32 s44, s42
    s_cbranch_scc1 K2S_OTH0
    s_not_b64 exec, s[96:97]
    s_add_u32 s46, s46, 1
    v_readlane_b32 s44, v208, s46
    v_pk_mul_f32 v[2:3], v[192:193], v[24:25] op_sel:[0,0] op_sel_hi:[1,0]
    v_pk_mul_f32 v[4:5], v[194:195], v[24:25] op_sel:[0,0] op_sel_hi:[1,0]
    v_cvt_pk_bf16_f32 v0, v192, v196
    v_pk_fma_f32 v[2:3], v[196:197], v[24:25], v[2:3] op_sel:[0,1,0] op_sel_hi:[1,1,1]
    v_pk_fma_f32 v[4:5], v[198:199], v[24:25], v[4:5] op_sel:[0,1,0] op_sel_hi:[1,1,1]
    v_cvt_pk_bf16_f32 v1, v200, v204
    v_pk_fma_f32 v[2:3], v[200:201], v[26:27], v[2:3] op_sel:[0,0,0] op_sel_hi:[1,0,1]
    v_pk_fma_f32 v[4:5], v[202:203], v[26:27], v[4:5] op_sel:[0,0,0] op_sel_hi:[1,0,1]
    v_pk_fma_f32 v[2:3], v[204:205], v[26:27], v[2:3] op_sel:[0,1,0] op_sel_hi:[1,1,1]
    v_pk_fma_f32 v[4:5], v[206:207], v[26:27], v[4:5] op_sel:[0,1,0] op_sel_hi:[1,1,1]
    ds_read_b128 v[192:195], v12
    ds_read_b128 v[196:199], v12
    ds_read_b128 v[200:203], v12
    ds_read_b128 v[204:207], v12
    ds_write_b64 v7, v[0:1]
    ds_write2_b64 v7, v[2:3], v[4:5] offset0:32 offset1:64
    s_or_saveexec_b64 s[96:97], -1
    s_not_b32 s40, s42
    v_mad_u32_u24 v7, s46, v217, v8
    s_min_u32 s42, s44, s47
    s_add_u32 s40, s40, s42
    s_cbranch_scc1 K2S_RET0
K2S_OTH0:
    s_cmp_eq_u32 s41, s42
    s_cbranch_scc1 K2S_LAST0
    s_mov_b32 s35, 3
    s_branch K2_OTH
.p2align 3
K2S_EVT1:
    s_cmp_lg_u32 s44, s42
    s_cbranch_scc1 K2S_OTH1
    s_not_b64 exec, s[96:97]
    s_add_u32 s46, s46, 1
    v_readlane_b32 s44, v208, s46
    v_pk_mul_f32 v[2:3], v[192:193], v[24:25] op_sel:[0,0] op_sel_hi:[1,0]
    v_pk_mul_f32 v[4:5], v[194:195], v[24:25] op_sel:[0,0] op_sel_hi:[1,0]
    v_cvt_pk_bf16_f32 v0, v192, v196
    v_pk_fma_f32 v[2:3], v[196:197], v[24:25], v[2:3] op_sel:[0,1,0] op_sel_hi:[1,1,1]
    v_pk_fma_f32 v[4:5], v[198:199], v[24:25], v[4:5] op_sel:[0,1,0] op_sel_hi:[1,1,1]
    v_cvt_pk_bf16_f32 v1, v200, v204
    v_pk_fma_f32 v[2:3], v[200:201], v[26:27], v[2:3] op_sel:[0,0,0] op_sel_hi:[1,0,1]
    v_pk_fma_f32 v[4:5], v[202:203], v[26:27], v[4:5] op_sel:[0,0,0] op_sel_hi:[1,0,1]
    v_pk_fma_f32 v[2:3], v[204:205], v[26:27], v[2:3] op_sel:[0,1,0] op_sel_hi:[1,1,1]
    v_pk_fma_f32 v[4:5], v[206:207], v[26:27], v[4:5] op_sel:[0,1,0] op_sel_hi:[1,1,1]
    ds_read_b128 v[192:195], v12
    ds_read_b128 v[196:199], v12
    ds_read_b128 v[200:203], v12
    ds_read_b128 v[204:207], v12
    ds_write_b64 v7, v[0:1]
    ds_write2_b64 v7, v[2:3], v[4:5] offset0:32 offset1:64
    s_or_saveexec_b64 s[96:97], -1
    s_not_b32 s40, s42
    v_mad_u32_u24 v7, s46, v217, v8
    s_min_u32 s42, s44, s47
    s_add_u32 s40, s40, s42
    s_cbranch_scc1 K2S_RET1
K2S_OTH1:
    s_cmp_eq_u32 s41, s42
    s_cbranch_scc1 K2S_LAST1
    s_mov_b32 s35, 4
    s_branch K2_OTH
.section .rodata,"a"
.p2align 6
.amdhsa_kernel k1_kernel
  .amdhsa_next_free_vgpr 104
  .amdhsa_next_free_sgpr 98
  .amdhsa_accum_offset 104
  .amdhsa_group_segment_fixed_size 0
  .amdhsa_kernarg_size 88
  .amdhsa_user_sgpr_count 2
  .amdhsa_user_sgpr_kernarg_segment_ptr 1
  .amdhsa_system_sgpr_workgroup_id_x 1
.end_amdhsa_kernel
.p2align 6
.amdhsa_kernel standalone__cheap_equivariant_egnn__graph_kernel
  .amdhsa_next_free_vgpr 256
  .amdhsa_next_free_sgpr 98
  .amdhsa_accum_offset 256
  .amdhsa_group_segment_fixed_size 0
  .amdhsa_kernarg_size 88
  .amdhsa_user_sgpr_count 2
  .amdhsa_user_sgpr_kernarg_segment_ptr 1
  .amdhsa_system_sgpr_workgroup_id_x 1
.end_amdhsa_kernel
```
